```python
import torch

def _softmax(x, axis=-1):
    return torch.softmax(x, dim=axis)
def _gelu(x):
    return torch.nn.functional.gelu(x, approximate="tanh")
def _silu(x):
    return torch.nn.functional.silu(x)
def _sigmoid(x):
    return torch.sigmoid(x)
def _layernorm(x, axis=-1, eps=1e-5):
    m = x.mean(dim=axis, keepdim=True)
    v = x.var(dim=axis, keepdim=True, unbiased=False)
    return (x - m) / torch.sqrt(v + eps)
def _scatter_add(tgt, idx, src, axis=0):
    return tgt.clone().index_add_(axis, idx, src)
def _segment_sum(src, seg, n):
    out = torch.zeros((n,) + src.shape[1:], dtype=src.dtype)
    return out.index_add_(0, seg, src)
def _pad(x, pw):
    flat = tuple(v for pair in reversed(pw) for v in pair)
    return torch.nn.functional.pad(x, flat)

kernel_name = 'parallel_sum__gqa_block_cached__geglu_ffn__decode'

def setup_inputs():

    _w = (lambda a: (lambda t: t.to(torch.bfloat16) if t.is_floating_point() else t)(torch.as_tensor(a)))
    def _A_setup():
        B, Sq, D = 2, 1, 512
        Hq, Hkv, Sk, Dh = 32, 8, 32768, 128
        assert Hq % Hkv == 0, (Hq, Hkv)
        return {
            "x": _w((lambda *s: torch.randn(*s, dtype=torch.bfloat16) * 0.05)(B, Sq, D)),
            "k_cache": _w((lambda *s: torch.randn(*s, dtype=torch.bfloat16) * 3.2)(B, Hkv, Sk, Dh)),
            "v_cache": _w((lambda *s: torch.randn(*s, dtype=torch.bfloat16) * 1.6)(B, Hkv, Sk, Dh)),
            "wq": _w((lambda *s: torch.randn(*s, dtype=torch.bfloat16) * 3.2)(D, Hq * Dh) * (D ** -0.5)),
            "wo": _w((lambda *s: torch.randn(*s, dtype=torch.bfloat16) * 1.6)(Hq * Dh, D) * ((Hq * Dh) ** -0.5)),
        }
    _A_in = _A_setup()

    def _B_setup():
        B, S, D, F = 2, 1, 512, 1792
        return {
            "x": _w((lambda *s: torch.randn(*s, dtype=torch.bfloat16) * 0.05)(B, S, D)),
            "w_gate": _w((lambda *s: torch.randn(*s, dtype=torch.bfloat16) * 0.05)(D, F)),
            "w_up": _w((lambda *s: torch.randn(*s, dtype=torch.bfloat16) * 0.05)(D, F)),
            "w_down": _w((lambda *s: torch.randn(*s, dtype=torch.bfloat16) * 0.05)(F, D)),
        }
    _B_in = _B_setup()

    return {
        "A_x": _A_in["x"],
        "A_k_cache": _A_in["k_cache"],
        "A_v_cache": _A_in["v_cache"],
        "A_wq": _A_in["wq"],
        "A_wo": _A_in["wo"],
        "B_x": _B_in["x"],
        "B_w_gate": _B_in["w_gate"],
        "B_w_up": _B_in["w_up"],
        "B_w_down": _B_in["w_down"],
    }

def reference(A_x, A_k_cache, A_v_cache, A_wq, A_wo, B_x, B_w_gate, B_w_up, B_w_down):
    def _A_ref(x, k_cache, v_cache, wq, wo):
        B, Sq, D = x.shape
        Hq, Dh = 32, 128
        Hkv = k_cache.shape[1]
        rep = Hq // Hkv
        q = (lambda x, *d: x.permute(*d))((x @ wq).reshape(B, Sq, Hq, Dh), 0, 2, 1, 3)
        k = (lambda x, n, axis: torch.repeat_interleave(x, n, dim=axis))(k_cache, rep, axis=1)
        v = (lambda x, n, axis: torch.repeat_interleave(x, n, dim=axis))(v_cache, rep, axis=1)
        scores = torch.einsum("bhqd,bhkd->bhqk", q, k) * (Dh ** -0.5)
        p = _softmax(scores, axis=-1)
        o = torch.einsum("bhqk,bhkd->bhqd", p, v)
        return (lambda x, *d: x.permute(*d))(o, 0, 2, 1, 3).reshape(B, Sq, Hq * Dh) @ wo

    def _B_ref(x, w_gate, w_up, w_down):
        return (_gelu(x @ w_gate) * (x @ w_up)) @ w_down

    x = A_x
    xn = _layernorm(x, axis=-1)
    return x + _A_ref(xn, A_k_cache, A_v_cache, A_wq, A_wo) + _B_ref(xn, B_w_gate, B_w_up, B_w_down)
```

```asm
; @launch grid=(256,1,1) block=(640,1,1) lds=159744
.amdgcn_target "amdgcn-amd-amdhsa--gfx950"
.text
.globl parallel_sum__gqa_block_cached__geglu_ffn__decode_kernel
.p2align 8
.type parallel_sum__gqa_block_cached__geglu_ffn__decode_kernel,@function
parallel_sum__gqa_block_cached__geglu_ffn__decode_kernel:
    s_cmp_ge_u32 s2, 256
    s_cbranch_scc1 L_abort
    s_load_dwordx16 s[16:31], s[0:1], 0
    s_load_dwordx8 s[32:39], s[0:1], 64
    s_lshr_b32 s5, s2, 3
    s_getpc_b64 s[80:81]
    s_lshl_b32 s6, s5, 9
    v_subrev_u32 v2, 448, v0
    v_cmp_gt_u32 vcc, 4, v2
    v_lshl_add_u32 v2, v2, 7, s6
    v_min_u32 v2, L_end-parallel_sum__gqa_block_cached__geglu_ffn__decode_kernel-64, v2
    s_and_b64 exec, exec, vcc
    s_cbranch_execz L_nopf
    v_mov_b32 v3, 0
    v_lshl_add_u64 v[2:3], v[2:3], 0, s[80:81]
    global_load_dword v165, v[2:3], off
L_nopf:
    s_mov_b64 exec, -1
    v_lshrrev_b32 v1, 6, v0
    v_and_b32 v0, 63, v0
    v_readfirstlane_b32 s3, v1
    v_mov_b32 v8, 0x26e00
    v_lshl_add_u32 v9, v0, 2, v8
    v_mov_b32 v11, 0
    ds_write_b32 v9, v11
    ds_write_b32 v9, v11 offset:256
    s_add_u32 s4, s2, 7
    s_and_b32 s4, s4, 7
    s_lshr_b32 s6, s5, 4
    s_and_b32 s7, s5, 15
    s_lshl_b32 s10, s4, 5
    s_add_u32 s10, s10, s5
    s_mov_b32 s15, 0x100000
    v_lshrrev_b32 v1, 4, v0
    v_lshlrev_b32 v3, 1, v1
    v_lshlrev_b32 v10, 4, v0
    v_lshrrev_b32 v12, 3, v0
    v_and_b32 v13, 7, v0
    v_xor_b32 v13, v13, v3
    v_lshlrev_b32 v13, 4, v13
    v_lshl_or_b32 v4, v12, 13, v13
    v_add_u32 v5, 64512, v4
    v_add_u32 v6, 129024, v4
    v_add_u32 v7, 193536, v4
    s_lshr_b32 s66, s5, 3
    s_lshl_b32 s60, s66, 10
    s_add_u32 s60, s60, s4
    s_lshl_b32 s60, s60, 3
    s_and_b32 s66, s5, 7
    s_add_u32 s60, s60, s66
    s_lshl_b32 s60, s60, 7
    s_mov_b32 s42, 0x400000
    s_mov_b32 s43, 0x20000
    s_mov_b32 s46, 2048
    s_mov_b32 s47, 0x20000
    s_mov_b32 m0, 0x20000
    s_cmp_lg_u32 s3, 0
    s_waitcnt lgkmcnt(0)
    s_cbranch_scc1 L_roles
    s_mov_b64 s[40:41], s[22:23]
    s_setprio 3
L_ldq:
    buffer_load_dwordx4 v4, s[40:43], s60 offen offset:0 nt lds
    buffer_load_dwordx4 v5, s[40:43], s60 offen offset:1024 nt lds
    buffer_load_dwordx4 v6, s[40:43], s60 offen offset:2048 nt lds
    buffer_load_dwordx4 v7, s[40:43], s60 offen offset:3072 nt lds
    s_add_u32 m0, m0, 0x1000
    s_add_u32 s60, s60, 0x40000
    s_cmp_lt_u32 m0, 0x24000
    s_cbranch_scc1 L_ldq
    s_barrier
    v_mul_u32_u24 v4, 3584, v12
    v_add_u32 v4, v4, v13
    v_add_u32 v5, 27648, v4
    v_add_u32 v6, 55296, v4
    v_add_u32 v7, 82944, v4
    s_mul_i32 s61, s66, 229376
    s_lshr_b32 s66, s10, 3
    s_lshl_b32 s66, s66, 7
    s_add_u32 s61, s61, s66
    s_cmp_lt_u32 s4, 7
    s_cselect_b32 s42, 0x1c0000, 0
    s_mov_b64 s[40:41], s[28:29]
    s_mov_b32 m0, 0x1c000
L_ldf2:
    s_mov_b32 s60, s61
L_ldf:
    s_waitcnt vmcnt(23)
    buffer_load_dwordx4 v4, s[40:43], s60 offen offset:0 nt lds
    s_waitcnt vmcnt(23)
    buffer_load_dwordx4 v5, s[40:43], s60 offen offset:1024 nt lds
    s_waitcnt vmcnt(23)
    buffer_load_dwordx4 v6, s[40:43], s60 offen offset:2048 nt lds
    s_waitcnt vmcnt(23)
    buffer_load_dwordx4 v7, s[40:43], s60 offen offset:3072 nt lds
    s_add_u32 m0, m0, 0x1000
    s_add_u32 s60, s60, 114688
    s_bitcmp1_b32 m0, 12
    s_cbranch_scc1 L_ldf
    s_mov_b64 s[40:41], s[30:31]
    s_bitcmp1_b32 m0, 13
    s_cbranch_scc1 L_ldf2
    v_and_b32 v2, 15, v0
    v_xor_b32 v2, v2, v3
    v_lshlrev_b32 v2, 4, v2
    v_lshl_or_b32 v4, v1, 8, v2
    v_xor_b32 v5, 0x80, v4
    v_xor_b32 v6, 16, v4
    v_xor_b32 v7, 0x90, v4
    s_lshl_b32 s64, s6, 3
    s_add_u32 s64, s64, s4
    s_lshl_b32 s64, s64, 4
    s_add_u32 s64, s64, s7
    s_lshl_b32 s64, s64, 1
    s_add_u32 s64, s64, s6
    s_lshl_b32 s64, s64, 1
    s_bfe_u32 s66, s7, 0x10002
    s_add_u32 s64, s64, s66
    s_lshl_b32 s64, s64, 17
    s_mov_b32 s60, s64
    s_mov_b32 s42, 0x8000000
    s_mov_b64 s[40:41], s[18:19]
    s_mov_b32 s62, 0
    s_mov_b32 s65, 0
    s_mov_b32 m0, 0
    s_mov_b32 s69, 2
    s_mov_b32 s63, 2
    s_mov_b32 s68, 0
    s_mov_b64 s[44:45], s[38:39]
    s_mov_b32 s46, 0x300000
    v_lshlrev_b32 v14, 3, v0
    v_mov_b32 v22, 0
    ds_read_b128 v[16:19], v8 offset:16
L_def:
    v_add_u32 v21, 1, v22
L_body2:
    s_waitcnt vmcnt(19)
    buffer_load_dwordx4 v4, s[40:43], s60 offen offset:0 nt lds
    v_add_u32 v21, 1, v21
    s_add_u32 s61, s60, 0x8000
    s_waitcnt vmcnt(19)
    buffer_load_dwordx4 v5, s[40:43], s60 offen offset:1024 nt lds
    s_or_b32 s65, s65, 0x8000
    s_add_u32 s65, s65, 0x1000
    s_waitcnt vmcnt(19)
    buffer_load_dwordx4 v6, s[40:43], s60 offen offset:2048 nt lds
    s_and_b32 s65, s65, 0x77000
    s_waitcnt vmcnt(19)
    buffer_load_dwordx4 v7, s[40:43], s60 offen offset:3072 nt lds
    ds_max_i32 v9, v21 offset:256
    s_add_u32 m0, m0, 0x1000
    s_waitcnt vmcnt(19)
    buffer_load_dwordx4 v4, s[40:43], s61 offen offset:0 nt lds
    s_xor_b32 s60, s65, s64
    s_waitcnt vmcnt(19)
    buffer_load_dwordx4 v5, s[40:43], s61 offen offset:1024 nt lds
    s_add_u32 s62, s62, 1
    s_waitcnt vmcnt(19)
    buffer_load_dwordx4 v6, s[40:43], s61 offen offset:2048 nt lds
    s_add_u32 s66, m0, 0x1000
    s_waitcnt vmcnt(19)
    buffer_load_dwordx4 v7, s[40:43], s61 offen offset:3072 nt lds
    s_and_b32 m0, s66, 0x1ffff
    s_cmp_lg_u32 s62, s69
    s_cbranch_scc1 L_body2
L_event:
    s_bitcmp1_b32 s62, 7
    s_cbranch_scc1 L_drain
    s_cmp_eq_u32 s62, s63
    s_cbranch_scc1 L_ctl
L_event2:
    s_waitcnt lgkmcnt(0)
    v_min3_i32 v20, v16, v17, v18
    v_min_i32 v20, v20, v19
    s_bitcmp1_b32 s62, 6
    v_readfirstlane_b32 s66, v20
L_event3:
    ds_read_b128 v[16:19], v8 offset:16
    s_cselect_b64 s[40:41], s[20:21], s[40:41]
    s_cmp_eq_u32 s66, 0
    s_cselect_b32 s69, 14, 16
    s_add_u32 s66, s66, s69
    s_or_b32 s69, s62, 63
    s_add_u32 s69, s69, 1
    s_min_u32 s69, s69, s66
    s_min_u32 s69, s69, s63
    v_mov_b32 v22, s62
    s_cmp_le_u32 s69, s62
    s_cbranch_scc1 L_full
    s_cmp_eq_u32 s68, 0
    s_cbranch_scc1 L_def
    s_branch L_var
L_full:
    s_sub_u32 s15, s15, 1
    s_cbranch_scc1 L_abort
    s_branch L_event2
L_roles:
    s_cmp_lg_u32 s3, 1
    s_cbranch_scc1 L_roles2
    s_mov_b64 s[44:45], s[16:17]
    s_setprio 2
    buffer_load_dwordx4 v[16:19], v10, s[44:47], 0 offen
    buffer_load_dwordx4 v[20:23], v10, s[44:47], 0 offen offset:1024
L_roles2:
    s_barrier
    s_cbranch_scc1 L_other
    s_branch L_aux
L_drain:
    v_mov_b32 v21, 129
    s_waitcnt vmcnt(24)
    ds_max_i32 v9, v21 offset:256
    v_mov_b32 v21, 130
    s_waitcnt vmcnt(16)
    ds_max_i32 v9, v21 offset:256
    v_mov_b32 v21, 131
    s_waitcnt vmcnt(8)
    ds_max_i32 v9, v21 offset:256
    v_mov_b32 v21, 132
    s_waitcnt vmcnt(0)
    ds_max_i32 v9, v21 offset:256
    s_endpgm
L_aux:
    s_lshr_b32 s67, s5, 3
    s_mov_b32 s48, s38
    s_mov_b32 s49, s39
    s_mov_b32 s50, 0x300000
    s_mov_b32 s51, 0x20000
    buffer_load_dword v24, v11, s[48:51], 0 offen sc1
    s_lshr_b32 s76, s10, 4
    s_lshl_b32 s76, s76, 2
    s_and_b32 s77, s7, 3
    s_add_u32 s76, s76, s77
    s_lshl_b32 s76, s76, 4
    s_and_b32 s77, s7, 12
    s_add_u32 s76, s76, s77
    s_add_u32 s76, s76, 0x1000
    s_mov_b64 exec, 1
    buffer_store_dword v11, v11, s[48:51], s76 offen
    s_mov_b64 exec, -1
    v_add_u32 v25, 0x26000, v10
    v_bfe_u32 v15, v0, 3, 1
    v_lshlrev_b32 v26, 10, v15
    v_lshl_add_u32 v26, v1, 3, v26
    v_add_u32 v26, 0x26000, v26
    s_lshl_b32 s66, s67, 8
    v_add_u32 v28, s66, v26
    s_and_b32 s66, s5, 7
    s_lshl_b32 s66, s66, 7
    v_add_u32 v26, s66, v26
    v_lshrrev_b32 v29, 2, v0
    v_lshlrev_b32 v29, 7, v29
    v_bfe_u32 v30, v0, 3, 2
    v_lshl_or_b32 v29, v30, 5, v29
    v_and_b32 v30, 3, v0
    v_lshl_or_b32 v29, v30, 3, v29
    v_add_u32 v160, 0x20000, v29
    v_xor_b32 v161, 32, v160
    v_xor_b32 v162, 64, v160
    v_xor_b32 v163, 96, v160
    v_lshlrev_b32 v27, 6, v30
    v_lshl_or_b32 v27, v1, 4, v27
    v_bfe_u32 v30, v0, 1, 2
    v_lshlrev_b32 v31, 7, v30
    v_lshl_or_b32 v31, v1, 5, v31
    v_and_b32 v30, 1, v0
    v_lshl_or_b32 v31, v30, 4, v31
    v_lshl_or_b32 v31, v15, 9, v31
    s_lshl_b32 s64, s10, 11
    s_add_u32 s64, s64, 0x10000
    s_mov_b32 s78, 0x7060500
    s_mov_b32 s79, 0x7060501
    s_mov_b32 s80, 0x7060502
    s_mov_b32 s81, 0x7060503
    buffer_load_dword v89, v31, s[48:51], s64 offen sc1
    s_mov_b32 s68, 0xaaaaaaaa
    s_mov_b32 s69, s68
    s_mov_b32 s70, 0xcccccccc
    s_mov_b32 s71, s70
    s_mov_b32 s72, 0xf0f0f0f0
    s_mov_b32 s73, s72
    s_waitcnt vmcnt(3)
    v_lshlrev_b32 v32, 16, v16
    v_and_b32 v33, 0xffff0000, v16
    v_lshlrev_b32 v34, 16, v17
    v_and_b32 v35, 0xffff0000, v17
    v_lshlrev_b32 v36, 16, v18
    v_and_b32 v37, 0xffff0000, v18
    v_lshlrev_b32 v38, 16, v19
    v_and_b32 v39, 0xffff0000, v19
    v_lshlrev_b32 v40, 16, v20
    v_and_b32 v41, 0xffff0000, v20
    v_lshlrev_b32 v42, 16, v21
    v_and_b32 v43, 0xffff0000, v21
    v_lshlrev_b32 v44, 16, v22
    v_and_b32 v45, 0xffff0000, v22
    v_lshlrev_b32 v46, 16, v23
    v_and_b32 v47, 0xffff0000, v23
    v_add_f32 v48, v32, v33
    v_add_f32 v49, v40, v41
    v_add_f32 v48, v48, v34
    v_add_f32 v49, v49, v42
    v_add_f32 v48, v48, v35
    v_add_f32 v49, v49, v43
    v_add_f32 v48, v48, v36
    v_add_f32 v49, v49, v44
    v_add_f32 v48, v48, v37
    v_add_f32 v49, v49, v45
    v_add_f32 v48, v48, v38
    v_add_f32 v49, v49, v46
    v_add_f32 v48, v48, v39
    v_add_f32 v49, v49, v47
    s_nop 0
    v_add_f32_dpp v48, v48, v48 quad_perm:[1,0,3,2] row_mask:0xf bank_mask:0xf
    v_add_f32_dpp v49, v49, v49 quad_perm:[1,0,3,2] row_mask:0xf bank_mask:0xf
    s_nop 0
    v_add_f32_dpp v48, v48, v48 quad_perm:[2,3,0,1] row_mask:0xf bank_mask:0xf
    v_add_f32_dpp v49, v49, v49 quad_perm:[2,3,0,1] row_mask:0xf bank_mask:0xf
    s_nop 0
    v_add_f32_dpp v48, v48, v48 row_half_mirror row_mask:0xf bank_mask:0xf
    v_add_f32_dpp v49, v49, v49 row_half_mirror row_mask:0xf bank_mask:0xf
    s_nop 0
    v_add_f32_dpp v48, v48, v48 row_mirror row_mask:0xf bank_mask:0xf
    v_add_f32_dpp v49, v49, v49 row_mirror row_mask:0xf bank_mask:0xf
    v_mov_b32 v50, v48
    v_mov_b32 v51, v49
    s_nop 0
    v_permlane16_swap_b32 v48, v50
    v_permlane16_swap_b32 v49, v51
    s_nop 0
    v_add_f32 v48, v48, v50
    v_add_f32 v49, v49, v51
    v_mov_b32 v50, v48
    v_mov_b32 v51, v49
    s_nop 0
    v_permlane32_swap_b32 v48, v50
    v_permlane32_swap_b32 v49, v51
    s_nop 0
    v_add_f32 v48, v48, v50
    v_add_f32 v49, v49, v51
    v_mul_f32 v48, 0x3b000000, v48
    v_mul_f32 v49, 0x3b000000, v49
    v_sub_f32 v52, v32, v48
    v_sub_f32 v53, v40, v49
    v_mul_f32 v54, v52, v52
    v_mul_f32 v55, v53, v53
    v_sub_f32 v52, v33, v48
    v_sub_f32 v53, v41, v49
    v_fmac_f32 v54, v52, v52
    v_fmac_f32 v55, v53, v53
    v_sub_f32 v52, v34, v48
    v_sub_f32 v53, v42, v49
    v_fmac_f32 v54, v52, v52
    v_fmac_f32 v55, v53, v53
    v_sub_f32 v52, v35, v48
    v_sub_f32 v53, v43, v49
    v_fmac_f32 v54, v52, v52
    v_fmac_f32 v55, v53, v53
    v_sub_f32 v52, v36, v48
    v_sub_f32 v53, v44, v49
    v_fmac_f32 v54, v52, v52
    v_fmac_f32 v55, v53, v53
    v_sub_f32 v52, v37, v48
    v_sub_f32 v53, v45, v49
    v_fmac_f32 v54, v52, v52
    v_fmac_f32 v55, v53, v53
    v_sub_f32 v52, v38, v48
    v_sub_f32 v53, v46, v49
    v_fmac_f32 v54, v52, v52
    v_fmac_f32 v55, v53, v53
    v_sub_f32 v52, v39, v48
    v_sub_f32 v53, v47, v49
    v_fmac_f32 v54, v52, v52
    v_fmac_f32 v55, v53, v53
    s_nop 0
    v_add_f32_dpp v54, v54, v54 quad_perm:[1,0,3,2] row_mask:0xf bank_mask:0xf
    v_add_f32_dpp v55, v55, v55 quad_perm:[1,0,3,2] row_mask:0xf bank_mask:0xf
    s_nop 0
    v_add_f32_dpp v54, v54, v54 quad_perm:[2,3,0,1] row_mask:0xf bank_mask:0xf
    v_add_f32_dpp v55, v55, v55 quad_perm:[2,3,0,1] row_mask:0xf bank_mask:0xf
    s_nop 0
    v_add_f32_dpp v54, v54, v54 row_half_mirror row_mask:0xf bank_mask:0xf
    v_add_f32_dpp v55, v55, v55 row_half_mirror row_mask:0xf bank_mask:0xf
    s_nop 0
    v_add_f32_dpp v54, v54, v54 row_mirror row_mask:0xf bank_mask:0xf
    v_add_f32_dpp v55, v55, v55 row_mirror row_mask:0xf bank_mask:0xf
    v_mov_b32 v50, v54
    v_mov_b32 v51, v55
    s_nop 0
    v_permlane16_swap_b32 v54, v50
    v_permlane16_swap_b32 v55, v51
    s_nop 0
    v_add_f32 v54, v54, v50
    v_add_f32 v55, v55, v51
    v_mov_b32 v50, v54
    v_mov_b32 v51, v55
    s_nop 0
    v_permlane32_swap_b32 v54, v50
    v_permlane32_swap_b32 v55, v51
    s_nop 0
    v_add_f32 v54, v54, v50
    v_add_f32 v55, v55, v51
    v_mul_f32 v54, 0x3b000000, v54
    v_mul_f32 v55, 0x3b000000, v55
    v_cvt_pk_bf16_f32 v50, v48, v49
    v_cvt_pk_bf16_f32 v51, v54, v55
    v_lshlrev_b32 v48, 16, v50
    v_and_b32 v49, 0xffff0000, v50
    v_lshlrev_b32 v54, 16, v51
    v_and_b32 v55, 0xffff0000, v51
    v_add_f32 v54, 0x3727c5ac, v54
    v_add_f32 v55, 0x3727c5ac, v55
    v_cvt_pk_bf16_f32 v51, v54, v55
    v_lshlrev_b32 v54, 16, v51
    v_and_b32 v55, 0xffff0000, v51
    v_sqrt_f32 v54, v54
    v_sqrt_f32 v55, v55
    s_nop 0
    v_cvt_pk_bf16_f32 v51, v54, v55
    v_lshlrev_b32 v54, 16, v51
    v_and_b32 v55, 0xffff0000, v51
    v_rcp_f32 v54, v54
    v_rcp_f32 v55, v55
    v_sub_f32 v32, v32, v48
    v_sub_f32 v33, v33, v48
    v_sub_f32 v34, v34, v48
    v_sub_f32 v35, v35, v48
    v_sub_f32 v36, v36, v48
    v_sub_f32 v37, v37, v48
    v_sub_f32 v38, v38, v48
    v_sub_f32 v39, v39, v48
    v_cvt_pk_bf16_f32 v56, v32, v33
    v_cvt_pk_bf16_f32 v57, v34, v35
    v_cvt_pk_bf16_f32 v58, v36, v37
    v_cvt_pk_bf16_f32 v59, v38, v39
    v_lshlrev_b32 v32, 16, v56
    v_and_b32 v33, 0xffff0000, v56
    v_lshlrev_b32 v34, 16, v57
    v_and_b32 v35, 0xffff0000, v57
    v_lshlrev_b32 v36, 16, v58
    v_and_b32 v37, 0xffff0000, v58
    v_lshlrev_b32 v38, 16, v59
    v_and_b32 v39, 0xffff0000, v59
    v_mul_f32 v32, v32, v54
    v_mul_f32 v33, v33, v54
    v_mul_f32 v34, v34, v54
    v_mul_f32 v35, v35, v54
    v_mul_f32 v36, v36, v54
    v_mul_f32 v37, v37, v54
    v_mul_f32 v38, v38, v54
    v_mul_f32 v39, v39, v54
    v_cvt_pk_bf16_f32 v56, v32, v33
    v_cvt_pk_bf16_f32 v57, v34, v35
    v_cvt_pk_bf16_f32 v58, v36, v37
    v_cvt_pk_bf16_f32 v59, v38, v39
    ds_write_b128 v25, v[56:59] offset:0
    v_sub_f32 v40, v40, v49
    v_sub_f32 v41, v41, v49
    v_sub_f32 v42, v42, v49
    v_sub_f32 v43, v43, v49
    v_sub_f32 v44, v44, v49
    v_sub_f32 v45, v45, v49
    v_sub_f32 v46, v46, v49
    v_sub_f32 v47, v47, v49
    v_cvt_pk_bf16_f32 v60, v40, v41
    v_cvt_pk_bf16_f32 v61, v42, v43
    v_cvt_pk_bf16_f32 v62, v44, v45
    v_cvt_pk_bf16_f32 v63, v46, v47
    v_lshlrev_b32 v40, 16, v60
    v_and_b32 v41, 0xffff0000, v60
    v_lshlrev_b32 v42, 16, v61
    v_and_b32 v43, 0xffff0000, v61
    v_lshlrev_b32 v44, 16, v62
    v_and_b32 v45, 0xffff0000, v62
    v_lshlrev_b32 v46, 16, v63
    v_and_b32 v47, 0xffff0000, v63
    v_mul_f32 v40, v40, v55
    v_mul_f32 v41, v41, v55
    v_mul_f32 v42, v42, v55
    v_mul_f32 v43, v43, v55
    v_mul_f32 v44, v44, v55
    v_mul_f32 v45, v45, v55
    v_mul_f32 v46, v46, v55
    v_mul_f32 v47, v47, v55
    v_cvt_pk_bf16_f32 v60, v40, v41
    v_cvt_pk_bf16_f32 v61, v42, v43
    v_cvt_pk_bf16_f32 v62, v44, v45
    v_cvt_pk_bf16_f32 v63, v46, v47
    ds_write_b128 v25, v[60:63] offset:1024
    s_waitcnt lgkmcnt(0)
    ds_read2_b64 v[64:67], v28 offset0:0 offset1:4
    ds_read2_b64 v[68:71], v28 offset0:8 offset1:12
    ds_read2_b64 v[72:75], v28 offset0:16 offset1:20
    ds_read2_b64 v[76:79], v28 offset0:24 offset1:28
    ds_read2_b64 v[80:83], v26 offset0:0 offset1:4
    ds_read2_b64 v[84:87], v26 offset0:8 offset1:12
L_w_1:
    ds_read_b32 v44, v8 offset:256
    s_sub_u32 s15, s15, 1
    s_cbranch_scc1 L_abort
    s_waitcnt lgkmcnt(0)
    v_readfirstlane_b32 s66, v44
    s_cmp_ge_i32 s66, 2
    s_cbranch_scc0 L_w_1
    s_waitcnt vmcnt(0)
    ds_read_b64_tr_b16 v[96:97], v160 offset:0
    ds_read_b64_tr_b16 v[98:99], v160 offset:2048
    ds_read_b64_tr_b16 v[100:101], v161 offset:0
    ds_read_b64_tr_b16 v[102:103], v161 offset:2048
    ds_read_b64_tr_b16 v[104:105], v162 offset:0
    ds_read_b64_tr_b16 v[106:107], v162 offset:2048
    ds_read_b64_tr_b16 v[108:109], v163 offset:0
    ds_read_b64_tr_b16 v[110:111], v163 offset:2048
    s_waitcnt lgkmcnt(4)
    ds_read_b64_tr_b16 v[112:113], v160 offset:4096
    ds_read_b64_tr_b16 v[114:115], v160 offset:6144
    ds_read_b64_tr_b16 v[116:117], v161 offset:4096
    ds_read_b64_tr_b16 v[118:119], v161 offset:6144
    ds_read_b64_tr_b16 v[120:121], v162 offset:4096
    ds_read_b64_tr_b16 v[122:123], v162 offset:6144
    ds_read_b64_tr_b16 v[124:125], v163 offset:4096
    ds_read_b64_tr_b16 v[126:127], v163 offset:6144
    s_waitcnt lgkmcnt(0)
    v_mfma_f32_16x16x32_bf16 v[32:35], v[96:99], v[64:67], 0
    v_mfma_f32_16x16x32_bf16 v[36:39], v[100:103], v[64:67], 0
    v_mfma_f32_16x16x32_bf16 v[40:43], v[104:107], v[64:67], 0
    v_mfma_f32_16x16x32_bf16 v[44:47], v[108:111], v[64:67], 0
    v_mfma_f32_16x16x32_bf16 v[32:35], v[112:115], v[68:71], v[32:35]
    v_mfma_f32_16x16x32_bf16 v[36:39], v[116:119], v[68:71], v[36:39]
    v_mfma_f32_16x16x32_bf16 v[40:43], v[120:123], v[68:71], v[40:43]
    v_mfma_f32_16x16x32_bf16 v[44:47], v[124:127], v[68:71], v[44:47]
    ds_read_b64_tr_b16 v[128:129], v160 offset:8192
    ds_read_b64_tr_b16 v[130:131], v160 offset:10240
    ds_read_b64_tr_b16 v[132:133], v161 offset:8192
    ds_read_b64_tr_b16 v[134:135], v161 offset:10240
    ds_read_b64_tr_b16 v[136:137], v162 offset:8192
    ds_read_b64_tr_b16 v[138:139], v162 offset:10240
    ds_read_b64_tr_b16 v[140:141], v163 offset:8192
    ds_read_b64_tr_b16 v[142:143], v163 offset:10240
    s_waitcnt lgkmcnt(4)
    ds_read_b64_tr_b16 v[144:145], v160 offset:12288
    ds_read_b64_tr_b16 v[146:147], v160 offset:14336
    ds_read_b64_tr_b16 v[148:149], v161 offset:12288
    ds_read_b64_tr_b16 v[150:151], v161 offset:14336
    ds_read_b64_tr_b16 v[152:153], v162 offset:12288
    ds_read_b64_tr_b16 v[154:155], v162 offset:14336
    ds_read_b64_tr_b16 v[156:157], v163 offset:12288
    ds_read_b64_tr_b16 v[158:159], v163 offset:14336
    s_waitcnt lgkmcnt(0)
    v_mfma_f32_16x16x32_bf16 v[32:35], v[128:131], v[72:75], v[32:35]
    v_mfma_f32_16x16x32_bf16 v[36:39], v[132:135], v[72:75], v[36:39]
    v_mfma_f32_16x16x32_bf16 v[40:43], v[136:139], v[72:75], v[40:43]
    v_mfma_f32_16x16x32_bf16 v[44:47], v[140:143], v[72:75], v[44:47]
    v_mfma_f32_16x16x32_bf16 v[32:35], v[144:147], v[76:79], v[32:35]
    v_mfma_f32_16x16x32_bf16 v[36:39], v[148:151], v[76:79], v[36:39]
    v_mfma_f32_16x16x32_bf16 v[40:43], v[152:155], v[76:79], v[40:43]
    v_mfma_f32_16x16x32_bf16 v[44:47], v[156:159], v[76:79], v[44:47]
    v_readfirstlane_b32 s65, v24
    s_add_u32 s65, s65, 0x4d2b7f35
    s_getreg_b32 s66, hwreg(HW_REG_XCC_ID, 0, 4)
    s_mul_i32 s66, s66, 0x10001
    s_xor_b32 s66, s66, s65
    v_mov_b32 v17, s66
    v_mov_b32 v19, s66
    v_cndmask_b32 v32, v32, v34, s[68:69]
    v_cndmask_b32 v33, v33, v35, s[68:69]
    v_cndmask_b32 v36, v36, v38, s[68:69]
    v_cndmask_b32 v37, v37, v39, s[68:69]
    v_cndmask_b32 v40, v40, v42, s[68:69]
    v_cndmask_b32 v41, v41, v43, s[68:69]
    v_cndmask_b32 v44, v44, v46, s[68:69]
    v_cndmask_b32 v45, v45, v47, s[68:69]
    v_cndmask_b32 v32, v32, v36, s[70:71]
    v_cndmask_b32 v33, v33, v37, s[70:71]
    v_cndmask_b32 v40, v40, v44, s[70:71]
    v_cndmask_b32 v41, v41, v45, s[70:71]
    v_cndmask_b32 v16, v32, v40, s[72:73]
    v_cndmask_b32 v18, v33, v41, s[72:73]
    buffer_store_dwordx4 v[16:19], v31, s[48:51], s64 offen
    v_mov_b32 v88, 1
    s_setprio 0
    s_add_u32 s64, s64, 0x100000
    v_mov_b32 v17, s65
    v_mov_b32 v19, s65
    s_mov_b32 s67, 1
    v_add_u32 v160, -16384, v160
    v_add_u32 v161, -16384, v161
    v_add_u32 v162, -16384, v162
    v_add_u32 v163, -16384, v163
L_w_2:
    ds_read_b32 v44, v8 offset:256
    s_sub_u32 s15, s15, 1
    s_cbranch_scc1 L_abort
    s_waitcnt lgkmcnt(0)
    v_readfirstlane_b32 s66, v44
    s_cmp_ge_i32 s66, 4
    s_cbranch_scc0 L_w_2
    ds_read_b64_tr_b16 v[96:97], v160 offset:0
    ds_read_b64_tr_b16 v[98:99], v160 offset:2048
    ds_read_b64_tr_b16 v[100:101], v161 offset:0
    ds_read_b64_tr_b16 v[102:103], v161 offset:2048
    ds_read_b64_tr_b16 v[104:105], v162 offset:0
    ds_read_b64_tr_b16 v[106:107], v162 offset:2048
    ds_read_b64_tr_b16 v[108:109], v163 offset:0
    ds_read_b64_tr_b16 v[110:111], v163 offset:2048
    s_waitcnt lgkmcnt(4)
    ds_read_b64_tr_b16 v[112:113], v160 offset:4096
    ds_read_b64_tr_b16 v[114:115], v160 offset:6144
    ds_read_b64_tr_b16 v[116:117], v161 offset:4096
    ds_read_b64_tr_b16 v[118:119], v161 offset:6144
    ds_read_b64_tr_b16 v[120:121], v162 offset:4096
    ds_read_b64_tr_b16 v[122:123], v162 offset:6144
    ds_read_b64_tr_b16 v[124:125], v163 offset:4096
    ds_read_b64_tr_b16 v[126:127], v163 offset:6144
    s_waitcnt lgkmcnt(0)
    v_mfma_f32_16x16x32_bf16 v[32:35], v[96:99], v[80:83], 0
    v_mfma_f32_16x16x32_bf16 v[36:39], v[100:103], v[80:83], 0
    v_mfma_f32_16x16x32_bf16 v[40:43], v[104:107], v[80:83], 0
    v_mfma_f32_16x16x32_bf16 v[44:47], v[108:111], v[80:83], 0
    v_mfma_f32_16x16x32_bf16 v[32:35], v[112:115], v[84:87], v[32:35]
    v_mfma_f32_16x16x32_bf16 v[36:39], v[116:119], v[84:87], v[36:39]
    v_mfma_f32_16x16x32_bf16 v[40:43], v[120:123], v[84:87], v[40:43]
    v_mfma_f32_16x16x32_bf16 v[44:47], v[124:127], v[84:87], v[44:47]
    ds_read_b64_tr_b16 v[128:129], v160 offset:8192
    ds_read_b64_tr_b16 v[130:131], v160 offset:10240
    ds_read_b64_tr_b16 v[132:133], v161 offset:8192
    ds_read_b64_tr_b16 v[134:135], v161 offset:10240
    ds_read_b64_tr_b16 v[136:137], v162 offset:8192
    ds_read_b64_tr_b16 v[138:139], v162 offset:10240
    ds_read_b64_tr_b16 v[140:141], v163 offset:8192
    ds_read_b64_tr_b16 v[142:143], v163 offset:10240
    s_waitcnt lgkmcnt(4)
    ds_read_b64_tr_b16 v[144:145], v160 offset:12288
    ds_read_b64_tr_b16 v[146:147], v160 offset:14336
    ds_read_b64_tr_b16 v[148:149], v161 offset:12288
    ds_read_b64_tr_b16 v[150:151], v161 offset:14336
    ds_read_b64_tr_b16 v[152:153], v162 offset:12288
    ds_read_b64_tr_b16 v[154:155], v162 offset:14336
    ds_read_b64_tr_b16 v[156:157], v163 offset:12288
    ds_read_b64_tr_b16 v[158:159], v163 offset:14336
    s_waitcnt lgkmcnt(0)
    v_mfma_f32_16x16x32_bf16 v[48:51], v[128:131], v[80:83], 0
    v_mfma_f32_16x16x32_bf16 v[52:55], v[132:135], v[80:83], 0
    v_mfma_f32_16x16x32_bf16 v[56:59], v[136:139], v[80:83], 0
    v_mfma_f32_16x16x32_bf16 v[60:63], v[140:143], v[80:83], 0
    v_mfma_f32_16x16x32_bf16 v[48:51], v[144:147], v[84:87], v[48:51]
    v_mfma_f32_16x16x32_bf16 v[52:55], v[148:151], v[84:87], v[52:55]
    v_mfma_f32_16x16x32_bf16 v[56:59], v[152:155], v[84:87], v[56:59]
    v_mfma_f32_16x16x32_bf16 v[60:63], v[156:159], v[84:87], v[60:63]
    s_mov_b64 exec, 1
    ds_write_b32 v8, v88 offset:80
    s_mov_b64 exec, -1
    s_nop 1
    v_cndmask_b32 v32, v32, v48, s[72:73]
    v_cndmask_b32 v33, v33, v49, s[72:73]
    v_cndmask_b32 v34, v34, v50, s[72:73]
    v_cndmask_b32 v35, v35, v51, s[72:73]
    v_cndmask_b32 v36, v36, v52, s[72:73]
    v_cndmask_b32 v37, v37, v53, s[72:73]
    v_cndmask_b32 v38, v38, v54, s[72:73]
    v_cndmask_b32 v39, v39, v55, s[72:73]
    v_cndmask_b32 v40, v40, v56, s[72:73]
    v_cndmask_b32 v41, v41, v57, s[72:73]
    v_cndmask_b32 v42, v42, v58, s[72:73]
    v_cndmask_b32 v43, v43, v59, s[72:73]
    v_cndmask_b32 v44, v44, v60, s[72:73]
    v_cndmask_b32 v45, v45, v61, s[72:73]
    v_cndmask_b32 v46, v46, v62, s[72:73]
    v_cndmask_b32 v47, v47, v63, s[72:73]
    v_cndmask_b32 v32, v32, v36, s[68:69]
    v_cndmask_b32 v33, v33, v37, s[68:69]
    v_cndmask_b32 v34, v34, v38, s[68:69]
    v_cndmask_b32 v35, v35, v39, s[68:69]
    v_cndmask_b32 v40, v40, v44, s[68:69]
    v_cndmask_b32 v41, v41, v45, s[68:69]
    v_cndmask_b32 v42, v42, v46, s[68:69]
    v_cndmask_b32 v43, v43, v47, s[68:69]
    v_cndmask_b32 v92, v32, v40, s[70:71]
    v_cndmask_b32 v93, v33, v41, s[70:71]
    v_cndmask_b32 v94, v34, v42, s[70:71]
    v_cndmask_b32 v95, v35, v43, s[70:71]
    v_add_u32 v92, 0x80, v92
    v_add_u32 v93, 0x80, v93
    v_add_u32 v94, 0x80, v94
    v_add_u32 v95, 0x80, v95
    v_perm_b32 v92, v92, v17, s78
    v_perm_b32 v93, v93, v17, s79
    v_perm_b32 v94, v94, v17, s80
    v_perm_b32 v95, v95, v17, s81
L_qserve:
    ds_read_b128 v[44:47], v8 offset:32
    ds_read_b32 v48, v8 offset:84
    s_sub_u32 s15, s15, 1
    s_cbranch_scc1 L_abort
    s_waitcnt lgkmcnt(0)
    v_min3_i32 v44, v44, v45, v46
    v_min_i32 v44, v44, v47
    v_readfirstlane_b32 s66, v48
    v_readfirstlane_b32 s84, v44
    s_and_b32 s66, s66, s67
    s_cbranch_scc0 L_qnob
    buffer_store_dwordx4 v[16:19], v31, s[48:51], s64 offen sc1
    s_mov_b32 s67, 0
L_qnob:
    s_cmp_eq_u32 s84, 0
    s_cbranch_scc1 L_qserve
    s_cmp_ge_u32 s4, 7
    s_cbranch_scc1 L_noffn1
    v_lshl_or_b32 v30, v15, 8, v27
    v_bfe_u32 v29, v0, 2, 1
    v_lshl_or_b32 v30, v29, 9, v30
    s_lshl_b32 s64, s10, 11
    s_add_u32 s64, s64, 0x10400
    s_cmp_eq_u32 s84, 2
    s_cbranch_scc0 L_far_3
    buffer_store_dwordx4 v[92:95], v30, s[48:51], s64 offen
    s_branch L_st_4
L_far_3:
    buffer_store_dwordx4 v[92:95], v30, s[48:51], s64 offen sc1
L_st_4:
L_noffn1:
    s_endpgm
L_other:
    s_mov_b32 s48, s38
    s_mov_b32 s49, s39
    s_mov_b32 s50, 0x300000
    s_mov_b32 s51, 0x20000
    buffer_load_dword v164, v11, s[48:51], 0 offen sc1
    s_cmp_ge_u32 s3, 6
    s_cbranch_scc1 L_tail
    s_mov_b64 exec, 0
    s_branch L_vlast
L_cpad:
    s_mov_b64 exec, -1
    s_setprio 1
    s_sub_u32 s60, s3, 2
    s_lshl_b32 s69, s4, 4
    s_add_u32 s69, s69, s60
    s_lshl_b32 s69, s69, 3
    s_add_u32 s69, s69, s6
    s_lshl_b32 s69, s69, 9
    s_add_u32 s69, s69, 0x10000
    s_add_u32 s70, s69, 16384
    s_add_u32 s71, s69, 32768
    s_add_u32 s72, s69, 49152
    v_lshrrev_b32 v12, 5, v0
    v_and_b32 v165, 0x1f0, v10
    v_lshl_or_b32 v165, v12, 11, v165
    s_mov_b32 s63, 0x3fb8aa3b
    s_mov_b32 s64, 0x3db504f3
    v_and_b32 v15, 3, v0
    v_lshlrev_b32 v160, 9, v15
    v_bfe_u32 v156, v0, 2, 1
    v_lshl_or_b32 v160, v156, 6, v160
    v_lshl_or_b32 v160, v1, 4, v160
    s_lshl_b32 s68, s10, 11
    s_lshl_b32 s65, s60, 7
    s_add_u32 s68, s68, s65
    s_add_u32 s68, s68, 0x10000
    s_lshl_b32 s73, s4, 2
    s_add_u32 s73, s73, s60
    s_lshl_b32 s73, s73, 1
    s_add_u32 s73, s73, s6
    s_lshl_b32 s73, s73, 2
    s_and_b32 s65, s7, 3
    s_add_u32 s73, s73, s65
    s_lshl_b32 s73, s73, 2
    s_lshr_b32 s65, s7, 2
    s_add_u32 s73, s73, s65
    s_lshl_b32 s73, s73, 4
    s_add_u32 s73, s73, 0x4000
    v_lshlrev_b32 v158, 4, v15
    v_lshl_or_b32 v158, v1, 6, v158
    v_add_u32 v158, 0x20000, v158
    v_bfe_u32 v155, v0, 2, 2
    v_lshl_add_u32 v157, v155, 10, v158
    s_lshl_b32 s65, s60, 8
    v_add_u32 v157, s65, v157
    s_add_u32 s65, s65, 0x26800
    v_lshl_add_u32 v2, v0, 2, s65
    v_lshlrev_b32 v3, 8, v15
    v_lshl_add_u32 v3, v1, 6, v3
    v_add_u32 v3, 0x26800, v3
    v_lshl_add_u32 v4, v15, 4, v8
    s_lshl_b32 s65, s60, 2
    v_add_u32 v5, s65, v4
    v_add_u32 v9, s65, v8
    v_and_b32 v14, 15, v0
    v_and_b32 v12, 7, v0
    v_lshlrev_b32 v12, 1, v12
    v_bfe_u32 v13, v0, 3, 1
    v_or_b32 v12, v12, v13
    v_lshlrev_b32 v13, 2, v1
    v_xor_b32 v12, v12, v13
    v_lshlrev_b32 v12, 4, v12
    v_lshl_or_b32 v12, v14, 8, v12
    s_lshl_b32 s65, s60, 13
    v_or_b32 v144, s65, v12
    v_xor_b32 v145, 0x10, v144
    v_xor_b32 v146, 0x20, v144
    v_xor_b32 v147, 0x30, v144
    v_xor_b32 v148, 0x10000, v144
    v_xor_b32 v149, 0x10010, v144
    v_xor_b32 v150, 0x10020, v144
    v_xor_b32 v151, 0x10030, v144
    v_lshrrev_b32 v12, 2, v0
    v_and_b32 v14, 7, v12
    v_lshlrev_b32 v14, 1, v14
    v_lshrrev_b32 v15, 5, v0
    v_or_b32 v14, v14, v15
    v_bfe_u32 v15, v0, 1, 1
    v_xor_b32 v14, v14, v15
    v_lshlrev_b32 v14, 4, v14
    v_lshl_or_b32 v13, v12, 8, v14
    v_and_b32 v15, 1, v0
    v_lshl_or_b32 v13, v15, 3, v13
    s_lshl_b32 s65, s60, 6
    v_xor_b32 v6, s65, v13
    v_xor_b32 v7, 32, v6
    s_mov_b32 s61, 0
    s_sub_u32 s62, s60, 3
    v_mov_b32 v152, 0xff800000
    v_mov_b32 v154, 0
    v_mov_b32 v24, 0
    v_mov_b32 v25, 0
    v_mov_b32 v26, 0
    v_mov_b32 v27, 0
    v_mov_b32 v28, 0
    v_mov_b32 v29, 0
    v_mov_b32 v30, 0
    v_mov_b32 v31, 0
    s_mov_b32 s76, 0x000f000f
    s_mov_b32 s77, s76
    s_lshl_b64 s[78:79], s[76:77], 4
    s_lshl_b64 s[80:81], s[76:77], 8
    s_lshl_b64 s[82:83], s[76:77], 12
    v_mov_b32 v159, 1
    s_mov_b32 s40, s16
    s_mov_b32 s41, s17
    s_mov_b32 s42, 0x800
    s_mov_b32 s43, 0x20000
    s_mov_b32 s44, s34
    s_mov_b32 s45, s35
    s_mov_b32 s46, 0x800
    s_mov_b32 s47, 0x20000
    s_lshl_b32 s85, s5, 2
    s_add_u32 s85, s85, s60
    s_lshl_b32 s85, s85, 4
    v_and_b32 v12, 1, v0
    v_bfe_u32 v13, v0, 2, 2
    v_lshlrev_b32 v13, 1, v13
    v_lshl_or_b32 v161, v12, 3, v13
    v_lshrrev_b32 v13, 1, v0
    v_lshlrev_b32 v13, 11, v13
    v_lshl_or_b32 v153, v12, 4, v13
    v_lshrrev_b32 v163, 3, v0
    v_lshlrev_b32 v163, 7, v163
    s_lshl_b32 s52, s6, 16
    s_and_b32 s53, s85, 0x3ff
    s_lshl_b32 s53, s53, 1
    s_add_u32 s52, s52, s53
    s_add_u32 s52, s52, 0xc0000
    s_mov_b32 s59, 0x2000
    s_cmp_lg_u32 s4, 0
    s_cbranch_scc1 L_nofin
    buffer_load_ushort v162, v161, s[40:43], s85 offen
    s_mov_b64 exec, 1
    buffer_store_short v11, v161, s[44:47], s85 offen
    s_mov_b64 exec, -1
L_nofin:
    s_waitcnt vmcnt(0)
    v_readfirstlane_b32 s67, v164
    s_add_u32 s67, s67, 0x4d2b7f35
    s_getreg_b32 s74, hwreg(HW_REG_XCC_ID, 0, 4)
    s_mul_i32 s74, s74, 0x10001
    s_xor_b32 s74, s74, s67
    s_bfe_u32 s54, s67, 0x80000
    s_bfe_u32 s55, s67, 0x80008
    s_bfe_u32 s56, s67, 0x80010
    s_bfe_u32 s57, s67, 0x80018
    v_lshlrev_b32 v162, 16, v162
    v_mov_b32 v164, s67
L_w_5:
    ds_read_b32 v155, v8 offset:80
    s_sub_u32 s15, s15, 1
    s_cbranch_scc1 L_abort
    s_waitcnt lgkmcnt(0)
    v_readfirstlane_b32 s65, v155
    s_cmp_ge_i32 s65, 1
    s_cbranch_scc0 L_w_5
    s_mov_b64 vcc, -1
    s_mov_b32 s66, 0
L_qpoll:
    s_add_u32 s66, s66, 1
    s_and_b32 s65, s66, 7
    s_cselect_b32 s65, 0, 0x100000
    s_cselect_b32 s75, s74, s67
    s_cselect_b64 exec, 0, 1
    ds_write_b32 v8, v159 offset:84
    s_mov_b64 exec, vcc
    v_add_u32 v15, s65, v165
    buffer_load_dwordx4 v[32:35], v15, s[48:51], s69 offen sc1
    buffer_load_dwordx4 v[36:39], v15, s[48:51], s70 offen sc1
    buffer_load_dwordx4 v[40:43], v15, s[48:51], s71 offen sc1
    buffer_load_dwordx4 v[44:47], v15, s[48:51], s72 offen sc1
    s_sub_u32 s15, s15, 1
    s_cbranch_scc1 L_abort
    s_waitcnt vmcnt(0)
    v_xor_b32 v33, s75, v33
    v_xor_b32 v35, s75, v35
    v_xor_b32 v37, s75, v37
    v_xor_b32 v39, s75, v39
    v_xor_b32 v41, s75, v41
    v_xor_b32 v43, s75, v43
    v_xor_b32 v45, s75, v45
    v_xor_b32 v47, s75, v47
    v_or3_b32 v155, v33, v35, v37
    v_or3_b32 v156, v39, v41, v43
    v_or3_b32 v155, v155, v45, v47
    v_or_b32 v155, v155, v156
    v_cmp_ne_u32 vcc, 0, v155
    s_cbranch_vccnz L_qpoll
    s_mov_b64 exec, -1
    v_add_f32 v32, v32, v36
    v_add_f32 v34, v34, v38
    v_add_f32 v32, v32, v40
    v_add_f32 v34, v34, v42
    v_add_f32 v32, v32, v44
    v_add_f32 v34, v34, v46
    v_cvt_pk_bf16_f32 v155, v32, v34
    ds_write_b32 v2, v155
    s_cmp_lt_u32 s66, 8
    s_cselect_b32 s65, 2, 1
    v_mov_b32 v156, s65
    s_mov_b64 exec, 1
    ds_write_b32 v9, v156 offset:32
    s_mov_b64 exec, -1
L_w4_6:
    ds_read_b128 v[16:19], v8 offset:32
    ds_read_b128 v[32:35], v3 offset:0
    ds_read_b128 v[36:39], v3 offset:16
    ds_read_b128 v[40:43], v3 offset:32
    ds_read_b128 v[44:47], v3 offset:48
    s_sub_u32 s15, s15, 1
    s_cbranch_scc1 L_abort
    s_waitcnt lgkmcnt(4)
    v_min3_i32 v16, v16, v17, v18
    v_min_i32 v16, v16, v19
    v_cmp_gt_i32 vcc, 1, v16
    s_waitcnt lgkmcnt(0)
    s_cbranch_vccnz L_w4_6
    v_readfirstlane_b32 s84, v16
    s_mov_b64 exec, 1
    ds_write_b32 v8, v16 offset:88
    s_mov_b64 exec, -1
    v_cndmask_b32 v64, 0, v32, s[76:77]
    v_cndmask_b32 v65, 0, v33, s[76:77]
    v_cndmask_b32 v66, 0, v34, s[76:77]
    v_cndmask_b32 v67, 0, v35, s[76:77]
    v_cndmask_b32 v68, 0, v36, s[76:77]
    v_cndmask_b32 v69, 0, v37, s[76:77]
    v_cndmask_b32 v70, 0, v38, s[76:77]
    v_cndmask_b32 v71, 0, v39, s[76:77]
    v_cndmask_b32 v72, 0, v40, s[76:77]
    v_cndmask_b32 v73, 0, v41, s[76:77]
    v_cndmask_b32 v74, 0, v42, s[76:77]
    v_cndmask_b32 v75, 0, v43, s[76:77]
    v_cndmask_b32 v76, 0, v44, s[76:77]
    v_cndmask_b32 v77, 0, v45, s[76:77]
    v_cndmask_b32 v78, 0, v46, s[76:77]
    v_cndmask_b32 v79, 0, v47, s[76:77]
    v_cndmask_b32 v80, 0, v32, s[78:79]
    v_cndmask_b32 v81, 0, v33, s[78:79]
    v_cndmask_b32 v82, 0, v34, s[78:79]
    v_cndmask_b32 v83, 0, v35, s[78:79]
    v_cndmask_b32 v84, 0, v36, s[78:79]
    v_cndmask_b32 v85, 0, v37, s[78:79]
    v_cndmask_b32 v86, 0, v38, s[78:79]
    v_cndmask_b32 v87, 0, v39, s[78:79]
    v_cndmask_b32 v88, 0, v40, s[78:79]
    v_cndmask_b32 v89, 0, v41, s[78:79]
    v_cndmask_b32 v90, 0, v42, s[78:79]
    v_cndmask_b32 v91, 0, v43, s[78:79]
    v_cndmask_b32 v92, 0, v44, s[78:79]
    v_cndmask_b32 v93, 0, v45, s[78:79]
    v_cndmask_b32 v94, 0, v46, s[78:79]
    v_cndmask_b32 v95, 0, v47, s[78:79]
    v_cndmask_b32 v96, 0, v32, s[80:81]
    v_cndmask_b32 v97, 0, v33, s[80:81]
    v_cndmask_b32 v98, 0, v34, s[80:81]
    v_cndmask_b32 v99, 0, v35, s[80:81]
    v_cndmask_b32 v100, 0, v36, s[80:81]
    v_cndmask_b32 v101, 0, v37, s[80:81]
    v_cndmask_b32 v102, 0, v38, s[80:81]
    v_cndmask_b32 v103, 0, v39, s[80:81]
    v_cndmask_b32 v104, 0, v40, s[80:81]
    v_cndmask_b32 v105, 0, v41, s[80:81]
    v_cndmask_b32 v106, 0, v42, s[80:81]
    v_cndmask_b32 v107, 0, v43, s[80:81]
    v_cndmask_b32 v108, 0, v44, s[80:81]
    v_cndmask_b32 v109, 0, v45, s[80:81]
    v_cndmask_b32 v110, 0, v46, s[80:81]
    v_cndmask_b32 v111, 0, v47, s[80:81]
    v_cndmask_b32 v112, 0, v32, s[82:83]
    v_cndmask_b32 v113, 0, v33, s[82:83]
    v_cndmask_b32 v114, 0, v34, s[82:83]
    v_cndmask_b32 v115, 0, v35, s[82:83]
    v_cndmask_b32 v116, 0, v36, s[82:83]
    v_cndmask_b32 v117, 0, v37, s[82:83]
    v_cndmask_b32 v118, 0, v38, s[82:83]
    v_cndmask_b32 v119, 0, v39, s[82:83]
    v_cndmask_b32 v120, 0, v40, s[82:83]
    v_cndmask_b32 v121, 0, v41, s[82:83]
    v_cndmask_b32 v122, 0, v42, s[82:83]
    v_cndmask_b32 v123, 0, v43, s[82:83]
    v_cndmask_b32 v124, 0, v44, s[82:83]
    v_cndmask_b32 v125, 0, v45, s[82:83]
    v_cndmask_b32 v126, 0, v46, s[82:83]
    v_cndmask_b32 v127, 0, v47, s[82:83]
L_kwin:
    s_add_u32 s62, s62, 4
    s_cmp_ge_i32 s61, s62
    s_cbranch_scc1 L_lo_7
L_ls_8:
    ds_read_b32 v155, v8 offset:256
    s_sub_u32 s15, s15, 1
    s_cbranch_scc1 L_abort
    s_waitcnt lgkmcnt(0)
    v_readfirstlane_b32 s61, v155
    s_sub_u32 s61, s61, 4
    s_cmp_ge_i32 s61, s62
    s_cbranch_scc0 L_ls_8
L_lo_7:
    ds_read_b128 v[32:35], v144 offset:0
    ds_read_b128 v[36:39], v145 offset:0
    ds_read_b128 v[40:43], v146 offset:0
    ds_read_b128 v[44:47], v147 offset:0
    ds_read_b128 v[48:51], v144 offset:4096
    ds_read_b128 v[52:55], v145 offset:4096
    ds_read_b128 v[56:59], v146 offset:4096
    ds_read_b128 v[60:63], v147 offset:4096
    s_add_u32 s65, s62, 3
    s_min_u32 s65, s65, 64
    v_mov_b32 v156, s65
    s_waitcnt lgkmcnt(4)
    v_mfma_f32_16x16x32_bf16 v[16:19], v[32:35], v[64:67], 0
    v_mfma_f32_16x16x32_bf16 v[16:19], v[36:39], v[68:71], v[16:19]
    v_mfma_f32_16x16x32_bf16 v[16:19], v[40:43], v[72:75], v[16:19]
    v_mfma_f32_16x16x32_bf16 v[16:19], v[44:47], v[76:79], v[16:19]
    s_waitcnt lgkmcnt(0)
    s_mov_b64 exec, 1
    ds_write_b32 v9, v156 offset:16
    s_mov_b64 exec, -1
    v_mfma_f32_16x16x32_bf16 v[20:23], v[48:51], v[64:67], 0
    v_mfma_f32_16x16x32_bf16 v[20:23], v[52:55], v[68:71], v[20:23]
    v_mfma_f32_16x16x32_bf16 v[20:23], v[56:59], v[72:75], v[20:23]
    v_mfma_f32_16x16x32_bf16 v[20:23], v[60:63], v[76:79], v[20:23]
    s_add_u32 s62, s62, 4
    s_cmp_ge_i32 s61, s62
    s_cbranch_scc1 L_lo_9
L_ls_10:
    ds_read_b32 v155, v8 offset:256
    s_sub_u32 s15, s15, 1
    s_cbranch_scc1 L_abort
    s_waitcnt lgkmcnt(0)
    v_readfirstlane_b32 s61, v155
    s_sub_u32 s61, s61, 4
    s_cmp_ge_i32 s61, s62
    s_cbranch_scc0 L_ls_10
L_lo_9:
    ds_read_b128 v[32:35], v144 offset:32768
    ds_read_b128 v[36:39], v145 offset:32768
    ds_read_b128 v[40:43], v146 offset:32768
    ds_read_b128 v[44:47], v147 offset:32768
    ds_read_b128 v[48:51], v144 offset:36864
    ds_read_b128 v[52:55], v145 offset:36864
    ds_read_b128 v[56:59], v146 offset:36864
    ds_read_b128 v[60:63], v147 offset:36864
    s_add_u32 s65, s62, 3
    s_min_u32 s65, s65, 64
    v_mov_b32 v156, s65
    s_waitcnt lgkmcnt(4)
    v_mfma_f32_16x16x32_bf16 v[16:19], v[32:35], v[80:83], v[16:19]
    v_mfma_f32_16x16x32_bf16 v[16:19], v[36:39], v[84:87], v[16:19]
    v_mfma_f32_16x16x32_bf16 v[16:19], v[40:43], v[88:91], v[16:19]
    v_mfma_f32_16x16x32_bf16 v[16:19], v[44:47], v[92:95], v[16:19]
    s_waitcnt lgkmcnt(0)
    s_mov_b64 exec, 1
    ds_write_b32 v9, v156 offset:16
    s_mov_b64 exec, -1
    v_mfma_f32_16x16x32_bf16 v[20:23], v[48:51], v[80:83], v[20:23]
    v_mfma_f32_16x16x32_bf16 v[20:23], v[52:55], v[84:87], v[20:23]
    v_mfma_f32_16x16x32_bf16 v[20:23], v[56:59], v[88:91], v[20:23]
    v_mfma_f32_16x16x32_bf16 v[20:23], v[60:63], v[92:95], v[20:23]
    s_add_u32 s62, s62, 4
    s_cmp_ge_i32 s61, s62
    s_cbranch_scc1 L_lo_11
L_ls_12:
    ds_read_b32 v155, v8 offset:256
    s_sub_u32 s15, s15, 1
    s_cbranch_scc1 L_abort
    s_waitcnt lgkmcnt(0)
    v_readfirstlane_b32 s61, v155
    s_sub_u32 s61, s61, 4
    s_cmp_ge_i32 s61, s62
    s_cbranch_scc0 L_ls_12
L_lo_11:
    ds_read_b128 v[32:35], v148 offset:0
    ds_read_b128 v[36:39], v149 offset:0
    ds_read_b128 v[40:43], v150 offset:0
    ds_read_b128 v[44:47], v151 offset:0
    ds_read_b128 v[48:51], v148 offset:4096
    ds_read_b128 v[52:55], v149 offset:4096
    ds_read_b128 v[56:59], v150 offset:4096
    ds_read_b128 v[60:63], v151 offset:4096
    s_add_u32 s65, s62, 3
    s_min_u32 s65, s65, 64
    v_mov_b32 v156, s65
    s_waitcnt lgkmcnt(4)
    v_mfma_f32_16x16x32_bf16 v[16:19], v[32:35], v[96:99], v[16:19]
    v_mfma_f32_16x16x32_bf16 v[16:19], v[36:39], v[100:103], v[16:19]
    v_mfma_f32_16x16x32_bf16 v[16:19], v[40:43], v[104:107], v[16:19]
    v_mfma_f32_16x16x32_bf16 v[16:19], v[44:47], v[108:111], v[16:19]
    s_waitcnt lgkmcnt(0)
    s_mov_b64 exec, 1
    ds_write_b32 v9, v156 offset:16
    s_mov_b64 exec, -1
    v_mfma_f32_16x16x32_bf16 v[20:23], v[48:51], v[96:99], v[20:23]
    v_mfma_f32_16x16x32_bf16 v[20:23], v[52:55], v[100:103], v[20:23]
    v_mfma_f32_16x16x32_bf16 v[20:23], v[56:59], v[104:107], v[20:23]
    v_mfma_f32_16x16x32_bf16 v[20:23], v[60:63], v[108:111], v[20:23]
    s_add_u32 s62, s62, 4
    s_cmp_ge_i32 s61, s62
    s_cbranch_scc1 L_lo_13
L_ls_14:
    ds_read_b32 v155, v8 offset:256
    s_sub_u32 s15, s15, 1
    s_cbranch_scc1 L_abort
    s_waitcnt lgkmcnt(0)
    v_readfirstlane_b32 s61, v155
    s_sub_u32 s61, s61, 4
    s_cmp_ge_i32 s61, s62
    s_cbranch_scc0 L_ls_14
L_lo_13:
    ds_read_b128 v[32:35], v148 offset:32768
    ds_read_b128 v[36:39], v149 offset:32768
    ds_read_b128 v[40:43], v150 offset:32768
    ds_read_b128 v[44:47], v151 offset:32768
    ds_read_b128 v[48:51], v148 offset:36864
    ds_read_b128 v[52:55], v149 offset:36864
    ds_read_b128 v[56:59], v150 offset:36864
    ds_read_b128 v[60:63], v151 offset:36864
    s_add_u32 s65, s62, 3
    s_min_u32 s65, s65, 64
    v_mov_b32 v156, s65
    s_waitcnt lgkmcnt(4)
    v_mfma_f32_16x16x32_bf16 v[16:19], v[32:35], v[112:115], v[16:19]
    v_mfma_f32_16x16x32_bf16 v[16:19], v[36:39], v[116:119], v[16:19]
    v_mfma_f32_16x16x32_bf16 v[16:19], v[40:43], v[120:123], v[16:19]
    v_mfma_f32_16x16x32_bf16 v[16:19], v[44:47], v[124:127], v[16:19]
    s_waitcnt lgkmcnt(0)
    s_mov_b64 exec, 1
    ds_write_b32 v9, v156 offset:16
    s_mov_b64 exec, -1
    v_mfma_f32_16x16x32_bf16 v[20:23], v[48:51], v[112:115], v[20:23]
    v_mfma_f32_16x16x32_bf16 v[20:23], v[52:55], v[116:119], v[20:23]
    v_mfma_f32_16x16x32_bf16 v[20:23], v[56:59], v[120:123], v[20:23]
    v_mfma_f32_16x16x32_bf16 v[20:23], v[60:63], v[124:127], v[20:23]
    v_mov_b32 v128, v132
    v_mov_b32 v129, v133
    v_mov_b32 v130, v134
    v_mov_b32 v131, v135
    v_mov_b32 v132, v136
    v_mov_b32 v133, v137
    v_mov_b32 v134, v138
    v_mov_b32 v135, v139
    v_mov_b32 v136, v140
    v_mov_b32 v137, v141
    v_mov_b32 v138, v142
    v_mov_b32 v139, v143
    v_cvt_pk_bf16_f32 v140, v16, v17
    v_cvt_pk_bf16_f32 v141, v18, v19
    v_cvt_pk_bf16_f32 v142, v20, v21
    v_cvt_pk_bf16_f32 v143, v22, v23
    v_lshlrev_b32 v16, 16, v140
    v_and_b32 v17, 0xffff0000, v140
    v_lshlrev_b32 v18, 16, v141
    v_and_b32 v19, 0xffff0000, v141
    v_lshlrev_b32 v20, 16, v142
    v_and_b32 v21, 0xffff0000, v142
    v_lshlrev_b32 v22, 16, v143
    v_and_b32 v23, 0xffff0000, v143
    v_mul_f32 v16, s64, v16
    v_mul_f32 v17, s64, v17
    v_mul_f32 v18, s64, v18
    v_mul_f32 v19, s64, v19
    v_mul_f32 v20, s64, v20
    v_mul_f32 v21, s64, v21
    v_mul_f32 v22, s64, v22
    v_mul_f32 v23, s64, v23
    v_cvt_pk_bf16_f32 v140, v16, v17
    v_cvt_pk_bf16_f32 v141, v18, v19
    v_cvt_pk_bf16_f32 v142, v20, v21
    v_cvt_pk_bf16_f32 v143, v22, v23
    v_max3_f32 v152, v152, v16, v17
    v_max3_f32 v155, v18, v19, v20
    v_max3_f32 v152, v152, v21, v22
    v_max3_f32 v152, v152, v155, v23
    s_cmp_lt_u32 s62, 60
    s_cbranch_scc1 L_kwin
    s_nop 1
    v_max_f32_dpp v152, v152, v152 row_ror:4 row_mask:0xf bank_mask:0xf
    s_nop 1
    v_max_f32_dpp v152, v152, v152 row_ror:8 row_mask:0xf bank_mask:0xf
    v_mov_b32 v155, v152
    s_nop 1
    v_permlane16_swap_b32 v152, v155
    s_nop 0
    v_max_f32 v152, v152, v155
    v_mov_b32 v155, v152
    s_nop 1
    v_permlane32_swap_b32 v152, v155
    s_nop 0
    v_max_f32 v152, v152, v155
    s_mov_b64 exec, 15
    ds_write_b32 v5, v152 offset:128
    s_mov_b64 exec, 1
    ds_write_b32 v9, v159 offset:48
    s_mov_b64 exec, -1
L_w4_15:
    ds_read_b128 v[16:19], v8 offset:96
    s_sub_u32 s15, s15, 1
    s_cbranch_scc1 L_abort
    s_waitcnt lgkmcnt(0)
    v_min3_i32 v16, v16, v17, v18
    v_min_i32 v16, v16, v19
    v_cmp_gt_i32 vcc, 1, v16
    s_cbranch_vccnz L_w4_15
L_w4_16:
    ds_read_b128 v[16:19], v8 offset:48
    ds_read_b128 v[20:23], v4 offset:128
    s_sub_u32 s15, s15, 1
    s_cbranch_scc1 L_abort
    s_waitcnt lgkmcnt(1)
    v_min3_i32 v16, v16, v17, v18
    v_min_i32 v16, v16, v19
    v_cmp_gt_i32 vcc, 1, v16
    s_waitcnt lgkmcnt(0)
    s_cbranch_vccnz L_w4_16
    v_max3_f32 v152, v20, v21, v22
    v_max_f32 v152, v152, v23
    v_cvt_pk_bf16_f32 v152, v152, v152
    v_and_b32 v152, 0xffff0000, v152
    v_mul_f32 v152, s63, v152
    s_mov_b32 s65, 4
L_pwin:
    v_lshlrev_b32 v16, 16, v128
    v_and_b32 v17, 0xffff0000, v128
    v_lshlrev_b32 v18, 16, v129
    v_and_b32 v19, 0xffff0000, v129
    v_lshlrev_b32 v20, 16, v130
    v_and_b32 v21, 0xffff0000, v130
    v_lshlrev_b32 v22, 16, v131
    v_and_b32 v23, 0xffff0000, v131
    v_fma_f32 v16, v16, s63, -v152
    v_fma_f32 v17, v17, s63, -v152
    v_fma_f32 v18, v18, s63, -v152
    v_fma_f32 v19, v19, s63, -v152
    v_fma_f32 v20, v20, s63, -v152
    v_fma_f32 v21, v21, s63, -v152
    v_fma_f32 v22, v22, s63, -v152
    v_fma_f32 v23, v23, s63, -v152
    v_exp_f32 v16, v16
    v_exp_f32 v17, v17
    v_exp_f32 v18, v18
    v_exp_f32 v19, v19
    v_exp_f32 v20, v20
    v_exp_f32 v21, v21
    v_exp_f32 v22, v22
    v_exp_f32 v23, v23
    v_mov_b32 v128, v132
    v_mov_b32 v129, v133
    v_mov_b32 v130, v134
    v_mov_b32 v131, v135
    v_mov_b32 v132, v136
    v_mov_b32 v133, v137
    v_mov_b32 v134, v138
    v_mov_b32 v135, v139
    v_mov_b32 v136, v140
    v_mov_b32 v137, v141
    v_mov_b32 v138, v142
    v_mov_b32 v139, v143
    s_waitcnt lgkmcnt(0)
    v_cvt_pk_bf16_f32 v32, v16, v17
    v_cvt_pk_bf16_f32 v33, v18, v19
    v_cvt_pk_bf16_f32 v34, v20, v21
    v_cvt_pk_bf16_f32 v35, v22, v23
    ds_write_b128 v157, v[32:35]
    v_add_f32 v154, v154, v16
    v_add_f32 v154, v154, v17
    v_add_f32 v154, v154, v18
    v_add_f32 v154, v154, v19
    v_add_f32 v154, v154, v20
    v_add_f32 v154, v154, v21
    v_add_f32 v154, v154, v22
    v_add_f32 v154, v154, v23
    v_add_u32 v157, 0x1000, v157
    s_sub_u32 s65, s65, 1
    s_cmp_lg_u32 s65, 0
    s_cbranch_scc1 L_pwin
    s_nop 1
    v_add_f32_dpp v154, v154, v154 row_ror:4 row_mask:0xf bank_mask:0xf
    s_nop 1
    v_add_f32_dpp v154, v154, v154 row_ror:8 row_mask:0xf bank_mask:0xf
    v_mov_b32 v155, v154
    s_nop 1
    v_permlane16_swap_b32 v154, v155
    s_nop 0
    v_add_f32 v154, v154, v155
    v_mov_b32 v155, v154
    s_nop 1
    v_permlane32_swap_b32 v154, v155
    s_nop 0
    v_add_f32 v154, v154, v155
    s_mov_b64 exec, 15
    ds_write_b32 v5, v154 offset:192
    s_mov_b64 exec, 1
    ds_write_b32 v9, v159 offset:64
    s_mov_b64 exec, -1
L_w4_17:
    ds_read_b128 v[16:19], v8 offset:64
    ds_read_b128 v[20:23], v4 offset:192
    s_sub_u32 s15, s15, 1
    s_cbranch_scc1 L_abort
    s_waitcnt lgkmcnt(1)
    v_min3_i32 v16, v16, v17, v18
    v_min_i32 v16, v16, v19
    v_cmp_gt_i32 vcc, 1, v16
    s_waitcnt lgkmcnt(0)
    s_cbranch_vccnz L_w4_17
    v_add_f32 v20, v20, v21
    v_add_f32 v22, v22, v23
    v_mov_b32 v16, v152
    v_mov_b32 v17, s67
    v_add_f32 v18, v20, v22
    v_mov_b32 v19, s67
    s_lshl_b64 exec, 1, s60
    s_cmp_eq_u32 s84, 2
    s_cbranch_scc0 L_far_18
    buffer_store_dwordx4 v[16:19], v11, s[48:51], s73 offen
    s_branch L_st_19
L_far_18:
    buffer_store_dwordx4 v[16:19], v11, s[48:51], s73 offen sc1
L_st_19:
    s_mov_b64 exec, -1
    s_mov_b32 s62, 64
L_vwin:
    ds_read_b128 v[40:43], v158 offset:0
    s_add_u32 s62, s62, 1
    s_cmp_ge_i32 s61, s62
    s_cbranch_scc1 L_lo_20
L_ls_21:
    ds_read_b32 v155, v8 offset:256
    s_sub_u32 s15, s15, 1
    s_cbranch_scc1 L_abort
    s_waitcnt lgkmcnt(0)
    v_readfirstlane_b32 s61, v155
    s_sub_u32 s61, s61, 4
    s_cmp_ge_i32 s61, s62
    s_cbranch_scc0 L_ls_21
L_lo_20:
    ds_read_b64_tr_b16 v[32:33], v6 offset:0
    ds_read_b64_tr_b16 v[34:35], v6 offset:4096
    ds_read_b64_tr_b16 v[36:37], v7 offset:0
    ds_read_b64_tr_b16 v[38:39], v7 offset:4096
    v_mov_b32 v156, s62
    s_waitcnt lgkmcnt(2)
    v_mfma_f32_16x16x32_bf16 v[24:27], v[32:35], v[40:43], v[24:27]
    s_waitcnt lgkmcnt(0)
    v_mfma_f32_16x16x32_bf16 v[28:31], v[36:39], v[40:43], v[28:31]
    s_mov_b64 exec, 1
    ds_write_b32 v9, v156 offset:16
    s_mov_b64 exec, -1
    ds_read_b128 v[40:43], v158 offset:256
    s_add_u32 s62, s62, 1
    s_cmp_ge_i32 s61, s62
    s_cbranch_scc1 L_lo_22
L_ls_23:
    ds_read_b32 v155, v8 offset:256
    s_sub_u32 s15, s15, 1
    s_cbranch_scc1 L_abort
    s_waitcnt lgkmcnt(0)
    v_readfirstlane_b32 s61, v155
    s_sub_u32 s61, s61, 4
    s_cmp_ge_i32 s61, s62
    s_cbranch_scc0 L_ls_23
L_lo_22:
    ds_read_b64_tr_b16 v[32:33], v6 offset:8192
    ds_read_b64_tr_b16 v[34:35], v6 offset:12288
    ds_read_b64_tr_b16 v[36:37], v7 offset:8192
    ds_read_b64_tr_b16 v[38:39], v7 offset:12288
    v_mov_b32 v156, s62
    s_waitcnt lgkmcnt(2)
    v_mfma_f32_16x16x32_bf16 v[24:27], v[32:35], v[40:43], v[24:27]
    s_waitcnt lgkmcnt(0)
    v_mfma_f32_16x16x32_bf16 v[28:31], v[36:39], v[40:43], v[28:31]
    s_mov_b64 exec, 1
    ds_write_b32 v9, v156 offset:16
    s_mov_b64 exec, -1
    ds_read_b128 v[40:43], v158 offset:512
    s_add_u32 s62, s62, 1
    s_cmp_ge_i32 s61, s62
    s_cbranch_scc1 L_lo_24
L_ls_25:
    ds_read_b32 v155, v8 offset:256
    s_sub_u32 s15, s15, 1
    s_cbranch_scc1 L_abort
    s_waitcnt lgkmcnt(0)
    v_readfirstlane_b32 s61, v155
    s_sub_u32 s61, s61, 4
    s_cmp_ge_i32 s61, s62
    s_cbranch_scc0 L_ls_25
L_lo_24:
    ds_read_b64_tr_b16 v[32:33], v6 offset:16384
    ds_read_b64_tr_b16 v[34:35], v6 offset:20480
    ds_read_b64_tr_b16 v[36:37], v7 offset:16384
    ds_read_b64_tr_b16 v[38:39], v7 offset:20480
    v_mov_b32 v156, s62
    s_waitcnt lgkmcnt(2)
    v_mfma_f32_16x16x32_bf16 v[24:27], v[32:35], v[40:43], v[24:27]
    s_waitcnt lgkmcnt(0)
    v_mfma_f32_16x16x32_bf16 v[28:31], v[36:39], v[40:43], v[28:31]
    s_mov_b64 exec, 1
    ds_write_b32 v9, v156 offset:16
    s_mov_b64 exec, -1
    ds_read_b128 v[40:43], v158 offset:768
    s_add_u32 s62, s62, 1
    s_cmp_eq_u32 s62, 128
    s_cbranch_scc1 L_vlast
    s_cmp_ge_i32 s61, s62
    s_cbranch_scc1 L_lo_26
L_ls_27:
    ds_read_b32 v155, v8 offset:256
    s_sub_u32 s15, s15, 1
    s_cbranch_scc1 L_abort
    s_waitcnt lgkmcnt(0)
    v_readfirstlane_b32 s61, v155
    s_sub_u32 s61, s61, 4
    s_cmp_ge_i32 s61, s62
    s_cbranch_scc0 L_ls_27
L_lo_26:
    ds_read_b64_tr_b16 v[32:33], v6 offset:24576
    ds_read_b64_tr_b16 v[34:35], v6 offset:28672
    ds_read_b64_tr_b16 v[36:37], v7 offset:24576
    ds_read_b64_tr_b16 v[38:39], v7 offset:28672
    v_mov_b32 v156, s62
    s_waitcnt lgkmcnt(2)
    v_mfma_f32_16x16x32_bf16 v[24:27], v[32:35], v[40:43], v[24:27]
    s_waitcnt lgkmcnt(0)
    v_mfma_f32_16x16x32_bf16 v[28:31], v[36:39], v[40:43], v[28:31]
    s_mov_b64 exec, 1
    ds_write_b32 v9, v156 offset:16
    s_mov_b64 exec, -1
    v_add_u32 v6, 0x8000, v6
    v_and_b32 v6, 0x1ffff, v6
    v_add_u32 v7, 0x8000, v7
    v_and_b32 v7, 0x1ffff, v7
    v_add_u32 v158, 0x400, v158
    s_cmp_lg_u32 s62, 120
    s_cbranch_scc1 L_vwin
L_w4_28:
    ds_read_b128 v[16:19], v8 offset:96
    s_sub_u32 s15, s15, 1
    s_cbranch_scc1 L_abort
    s_waitcnt lgkmcnt(0)
    v_min3_i32 v16, v16, v17, v18
    v_min_i32 v16, v16, v19
    v_cmp_gt_i32 vcc, 2, v16
    s_cbranch_vccnz L_w4_28
    s_branch L_vwin
.p2align 6
L_vlast:
    s_cbranch_execz L_cpad
L_vl2:
    ds_read_b32 v155, v8 offset:256
    ds_read_b64_tr_b16 v[32:33], v6 offset:24576
    ds_read_b64_tr_b16 v[34:35], v6 offset:28672
    ds_read_b64_tr_b16 v[36:37], v7 offset:24576
    ds_read_b64_tr_b16 v[38:39], v7 offset:28672
    s_sub_u32 s15, s15, 1
    s_cbranch_scc1 L_abort
    s_waitcnt lgkmcnt(4)
    v_cmp_gt_i32 vcc, 132, v155
    s_cbranch_vccnz L_vl2
    s_waitcnt lgkmcnt(2)
    v_mfma_f32_16x16x32_bf16 v[24:27], v[32:35], v[40:43], v[24:27]
    s_waitcnt lgkmcnt(0)
    v_mfma_f32_16x16x32_bf16 v[28:31], v[36:39], v[40:43], v[28:31]
    s_cmp_eq_u32 s84, 2
    s_mov_b32 s86, 0x00ff00ff
    s_mov_b32 s87, s86
    s_nop 4
    v_mov_b32_dpp v24, v28 row_shr:4 row_mask:0xf bank_mask:0x2
    v_mov_b32_dpp v25, v29 row_shr:4 row_mask:0xf bank_mask:0x2
    v_mov_b32_dpp v26, v30 row_shr:4 row_mask:0xf bank_mask:0x2
    v_mov_b32_dpp v27, v31 row_shr:4 row_mask:0xf bank_mask:0x2
    s_mov_b64 exec, s[86:87]
    s_cbranch_scc0 L_o_far
    buffer_store_dwordx4 v[24:27], v160, s[48:51], s68 offen
L_o_pub:
L_o_end:
    s_cmp_lg_u32 s4, 0
    s_cbranch_scc1 L_c_end
    s_mov_b64 exec, -1
L_w4_29:
    ds_read_b128 v[16:19], v8 offset:0
    s_sub_u32 s15, s15, 1
    s_cbranch_scc1 L_abort
    s_waitcnt lgkmcnt(0)
    v_min3_i32 v16, v16, v17, v18
    v_min_i32 v16, v16, v19
    v_cmp_gt_i32 vcc, 1, v16
    s_cbranch_vccnz L_w4_29
    s_mov_b64 s[86:87], -1
    v_not_b32 v13, v164
L_ipoll:
    buffer_load_dword v13, v163, s[48:51], s59 offen sc1
    s_sub_u32 s15, s15, 1
    s_cbranch_scc1 L_abort
    s_waitcnt vmcnt(0)
    v_cmp_ne_u32 vcc, v164, v13
    s_cbranch_vccnz L_ipoll
L_ypoll:
    buffer_load_dwordx4 v[32:35], v153, s[48:51], s52 offen sc1
    s_sub_u32 s15, s15, 1
    s_cbranch_scc1 L_abort
    s_waitcnt vmcnt(0)
    v_xor_b32 v32, s54, v32
    v_xor_b32 v33, s55, v33
    v_xor_b32 v34, s56, v34
    v_xor_b32 v35, s57, v35
    v_or3_b32 v155, v32, v33, v34
    v_or_b32 v155, v155, v35
    v_and_b32 v155, 0xff, v155
    v_cmp_ne_u32 vcc, 0, v155
    s_and_b64 exec, exec, vcc
    s_cbranch_scc1 L_ypoll
    s_mov_b64 exec, -1
    v_add_f32_dpp v36, v32, v32 row_ror:12 row_mask:0xf bank_mask:0x5
    v_add_f32_dpp v37, v34, v34 row_ror:12 row_mask:0xf bank_mask:0x5
    s_nop 0
    v_add_f32_dpp v36, v33, v33 row_ror:4 row_mask:0xf bank_mask:0xa
    v_add_f32_dpp v37, v35, v35 row_ror:4 row_mask:0xf bank_mask:0xa
    s_nop 0
    v_add_f32_dpp v38, v36, v36 row_ror:8 row_mask:0xf bank_mask:0x3
    s_nop 1
    v_add_f32_dpp v38, v37, v37 row_ror:8 row_mask:0xf bank_mask:0xc
    s_nop 1
    v_add_f32_dpp v38, v38, v38 quad_perm:[2,3,0,1] row_mask:0xf bank_mask:0xf
    v_mov_b32 v39, v38
    s_nop 1
    v_permlane16_swap_b32 v38, v39
    s_nop 0
    v_add_f32 v38, v38, v39
    v_mov_b32 v39, v38
    s_nop 1
    v_permlane32_swap_b32 v38, v39
    s_nop 0
    v_add_f32 v38, v38, v39
    v_add_f32 v38, v38, v162
    s_mov_b64 exec, 0x3333
    v_cvt_pk_bf16_f32 v38, v38, v38
    buffer_store_short v38, v161, s[44:47], s85 offen
    s_cmp_lg_u32 s85, 0
    s_cbranch_scc1 L_c_st
    s_mov_b64 exec, 1
    buffer_store_dword v164, v11, s[48:51], 0 offen
L_c_st:
L_c_end:
    s_endpgm
L_o_far:
    buffer_store_dwordx4 v[24:27], v160, s[48:51], s68 offen sc1
    s_branch L_o_pub
L_tail:
    s_mov_b64 exec, 0
    s_branch L_tend
L_tpad:
    s_mov_b64 exec, -1
    s_sub_u32 s60, s3, 6
    s_mov_b32 s40, s24
    s_mov_b32 s41, s25
    s_mov_b32 s42, 0x400000
    s_mov_b32 s43, 0x20000
    s_mov_b32 s44, s32
    s_mov_b32 s45, s33
    s_mov_b32 s46, 0x1c0000
    s_mov_b32 s47, 0x20000
    v_lshl_or_b32 v4, v12, 10, v13
    v_add_u32 v5, 7168, v4
    v_add_u32 v6, 14336, v4
    v_add_u32 v7, 21504, v4
    s_lshr_b32 s61, s10, 3
    s_lshl_b32 s64, s61, 2
    s_add_u32 s64, s64, s60
    s_lshl_b32 s63, s64, 15
    s_lshl_b32 s64, s64, 14
    s_and_b32 s66, s5, 7
    s_lshl_b32 s65, s66, 7
    s_add_u32 s63, s63, s65
    s_add_u32 s64, s64, s65
    s_cmp_lt_u32 s4, 7
    s_cselect_b32 s64, s64, 0
    s_cselect_b32 s46, s46, 0
    s_lshl_b32 s83, s60, 12
    s_lshl_b32 s84, s60, 11
    s_add_u32 m0, s84, 0x24000
    s_lshl_b32 s69, s61, 9
    buffer_load_dwordx4 v4, s[44:47], s64 offen offset:0 nt lds
    buffer_load_dwordx4 v5, s[44:47], s64 offen offset:1024 nt lds
    s_add_u32 s69, s69, 0x4000
    v_lshlrev_b32 v14, 7, v0
    s_lshl_b32 s96, s4, 2
    s_add_u32 s96, s96, s60
    s_lshl_b32 s96, s96, 7
    s_add_u32 s96, s96, 0x3000
    s_mov_b64 exec, 1
    buffer_load_dword v16, v11, s[48:51], s96 offen sc1
    s_cmp_eq_u32 s60, 0
    s_cbranch_scc1 L_tt_32
    s_cmp_ge_u32 s60, 2
    s_cbranch_scc1 L_tt_30
    s_lshl_b32 s65, s10, 11
    s_add_u32 s65, s65, 0x10400
    s_mov_b64 exec, 0xff
    buffer_load_dword v17, v14, s[48:51], s65 offen sc1
    s_branch L_tt_32
L_tt_30:
    s_cmp_eq_u32 s60, 2
    s_cbranch_scc0 L_tt_31
    s_mov_b64 exec, 15
    buffer_load_dword v17, v14, s[48:51], s69 offen sc1
    s_branch L_tt_32
L_tt_31:
    s_mov_b64 exec, 1
    buffer_load_dword v17, v11, s[40:43], s63 offen nt
    s_mov_b32 s52, s18
    s_mov_b32 s53, s19
    s_mov_b32 s54, 0x8000000
    s_mov_b32 s55, 0x20000
    s_mov_b32 s56, s20
    s_mov_b32 s57, s21
    s_mov_b32 s58, 0x8000000
    s_mov_b32 s59, 0x20000
    s_lshl_b32 s65, s6, 3
    s_add_u32 s65, s65, s4
    s_lshl_b32 s65, s65, 4
    s_add_u32 s65, s65, s7
    s_lshl_b32 s65, s65, 19
    buffer_load_dword v18, v11, s[52:55], s65 offen nt
    buffer_load_dword v19, v11, s[56:59], s65 offen nt
L_tt_32:
    s_mov_b64 exec, -1
    v_lshrrev_b32 v144, 2, v0
    v_lshlrev_b32 v144, 7, v144
    v_bfe_u32 v14, v0, 3, 2
    v_xor_b32 v14, s60, v14
    v_lshl_or_b32 v144, v14, 5, v144
    v_and_b32 v2, 3, v0
    v_lshl_or_b32 v144, v2, 3, v144
    v_add_u32 v145, 0x24000, v144
    v_bfe_u32 v15, v0, 3, 1
    v_lshlrev_b32 v161, 6, v12
    v_lshrrev_b32 v14, 5, v0
    v_bfe_u32 v3, v0, 3, 2
    v_and_b32 v162, 7, v0
    v_lshlrev_b32 v162, 4, v162
    v_lshl_or_b32 v162, v3, 11, v162
    v_lshl_or_b32 v162, v14, 15, v162
    s_lshl_b32 s70, s4, 7
    s_lshr_b32 s65, s5, 3
    s_add_u32 s70, s70, s65
    s_lshl_b32 s70, s70, 2
    s_add_u32 s70, s70, s60
    s_lshl_b32 s70, s70, 7
    s_add_u32 s70, s70, 0x10000
    s_add_u32 s71, s70, 8192
    s_add_u32 s72, s70, 16384
    s_add_u32 s73, s70, 24576
    v_lshlrev_b32 v146, 6, v15
    v_lshl_or_b32 v146, v1, 4, v146
    v_add_u32 v146, 0x26c00, v146
    v_lshlrev_b32 v147, 6, v14
    v_lshl_or_b32 v147, v2, 4, v147
    v_bfe_u32 v14, v0, 2, 1
    v_lshl_or_b32 v147, v14, 3, v147
    v_bfe_u32 v14, v0, 4, 1
    v_lshl_or_b32 v147, v14, 2, v147
    s_lshl_b32 s65, s60, 7
    v_add_u32 v147, s65, v147
    v_add_u32 v147, 0x26c00, v147
    v_and_b32 v30, 7, v0
    v_lshlrev_b32 v154, 4, v30
    v_lshl_or_b32 v154, v12, 9, v154
    v_lshlrev_b32 v30, 11, v30
    v_lshl_or_b32 v30, v15, 8, v30
    v_lshl_or_b32 v30, v1, 4, v30
    s_lshl_b32 s75, s61, 8
    s_add_u32 s75, s75, s60
    s_lshl_b32 s75, s75, 6
    s_add_u32 s75, s75, 0x10400
    v_lshlrev_b32 v163, 16, v15
    v_lshl_or_b32 v163, v1, 4, v163
    s_lshl_b32 s74, s10, 2
    s_add_u32 s74, s74, s60
    s_lshl_b32 s74, s74, 6
    s_add_u32 s74, s74, 0xc0000
    v_lshlrev_b32 v148, 3, v0
    v_add_u32 v148, 0x26000, v148
    s_lshl_b32 s65, s60, 9
    v_add_u32 v149, s65, v148
    s_lshl_b32 s65, s60, 2
    v_add_u32 v9, s65, v8
    v_mov_b32 v23, 1
    s_waitcnt vmcnt(0)
    v_readfirstlane_b32 s67, v164
    s_add_u32 s67, s67, 0x4d2b7f35
    s_mov_b32 s85, 0xffffff00
    v_mov_b32 v164, s67
    s_lshl_b32 s78, s4, 7
    s_add_u32 s78, s78, 0x2000
    v_bfe_u32 v150, s67, 0, 8
    v_bfe_u32 v151, s67, 8, 8
    v_bfe_u32 v152, s67, 16, 8
    v_bfe_u32 v153, s67, 24, 8
    s_lshl_b32 s66, s60, 2
    s_add_u32 s66, s66, 24
L_w_33:
    ds_read_b32 v20, v8 offset:16
    s_sub_u32 s15, s15, 1
    s_cbranch_scc1 L_abort
    s_waitcnt lgkmcnt(0)
    v_readfirstlane_b32 s65, v20
    s_cmp_ge_i32 s65, s66
    s_cbranch_scc0 L_w_33
    v_mov_b32 v40, 0
    v_mov_b32 v41, 0
    s_cmp_ge_u32 s4, 7
    s_cbranch_scc1 L_noffn2
    s_bfe_u32 s86, s67, 0x80000
    s_bfe_u32 s87, s67, 0x80008
    s_bfe_u32 s88, s67, 0x80010
    s_bfe_u32 s89, s67, 0x80018
L_fpoll_34:
    buffer_load_dwordx4 v[44:47], v30, s[48:51], s75 offen offset:0 sc1
    buffer_load_dwordx4 v[48:51], v30, s[48:51], s75 offen offset:512 sc1
    s_sub_u32 s15, s15, 1
    s_cbranch_scc1 L_abort
    s_waitcnt vmcnt(0)
    v_xor_b32 v44, s86, v44
    v_xor_b32 v45, s87, v45
    v_xor_b32 v46, s88, v46
    v_xor_b32 v47, s89, v47
    v_xor_b32 v48, s86, v48
    v_xor_b32 v49, s87, v49
    v_xor_b32 v50, s88, v50
    v_xor_b32 v51, s89, v51
    v_or3_b32 v60, v44, v45, v46
    v_or3_b32 v60, v60, v47, v48
    v_or3_b32 v60, v60, v49, v50
    v_or_b32 v60, v60, v51
    v_and_b32 v60, 0xff, v60
    v_cmp_ne_u32 vcc, 0, v60
    s_cbranch_vccnz L_fpoll_34
    v_add_f32_dpp v44, v44, v44 quad_perm:[1,0,3,2] row_mask:0xf bank_mask:0xf
    v_add_f32_dpp v45, v45, v45 quad_perm:[1,0,3,2] row_mask:0xf bank_mask:0xf
    v_add_f32_dpp v46, v46, v46 quad_perm:[1,0,3,2] row_mask:0xf bank_mask:0xf
    v_add_f32_dpp v47, v47, v47 quad_perm:[1,0,3,2] row_mask:0xf bank_mask:0xf
    v_add_f32_dpp v48, v48, v48 quad_perm:[1,0,3,2] row_mask:0xf bank_mask:0xf
    v_add_f32_dpp v49, v49, v49 quad_perm:[1,0,3,2] row_mask:0xf bank_mask:0xf
    v_add_f32_dpp v50, v50, v50 quad_perm:[1,0,3,2] row_mask:0xf bank_mask:0xf
    v_add_f32_dpp v51, v51, v51 quad_perm:[1,0,3,2] row_mask:0xf bank_mask:0xf
    v_add_f32_dpp v44, v44, v44 quad_perm:[2,3,0,1] row_mask:0xf bank_mask:0xf
    v_add_f32_dpp v45, v45, v45 quad_perm:[2,3,0,1] row_mask:0xf bank_mask:0xf
    v_add_f32_dpp v46, v46, v46 quad_perm:[2,3,0,1] row_mask:0xf bank_mask:0xf
    v_add_f32_dpp v47, v47, v47 quad_perm:[2,3,0,1] row_mask:0xf bank_mask:0xf
    v_add_f32_dpp v48, v48, v48 quad_perm:[2,3,0,1] row_mask:0xf bank_mask:0xf
    v_add_f32_dpp v49, v49, v49 quad_perm:[2,3,0,1] row_mask:0xf bank_mask:0xf
    v_add_f32_dpp v50, v50, v50 quad_perm:[2,3,0,1] row_mask:0xf bank_mask:0xf
    v_add_f32_dpp v51, v51, v51 quad_perm:[2,3,0,1] row_mask:0xf bank_mask:0xf
    v_add_f32_dpp v44, v44, v44 row_half_mirror row_mask:0xf bank_mask:0xf
    v_add_f32_dpp v45, v45, v45 row_half_mirror row_mask:0xf bank_mask:0xf
    v_add_f32_dpp v46, v46, v46 row_half_mirror row_mask:0xf bank_mask:0xf
    v_add_f32_dpp v47, v47, v47 row_half_mirror row_mask:0xf bank_mask:0xf
    v_add_f32_dpp v48, v48, v48 row_half_mirror row_mask:0xf bank_mask:0xf
    v_add_f32_dpp v49, v49, v49 row_half_mirror row_mask:0xf bank_mask:0xf
    v_add_f32_dpp v50, v50, v50 row_half_mirror row_mask:0xf bank_mask:0xf
    v_add_f32_dpp v51, v51, v51 row_half_mirror row_mask:0xf bank_mask:0xf
    v_cvt_pk_bf16_f32 v40, v44, v45
    v_lshlrev_b32 v32, 16, v40
    v_and_b32 v33, 0xffff0000, v40
    v_cvt_pk_bf16_f32 v40, v46, v47
    v_lshlrev_b32 v34, 16, v40
    v_and_b32 v35, 0xffff0000, v40
    v_cvt_pk_bf16_f32 v40, v48, v49
    v_lshlrev_b32 v36, 16, v40
    v_and_b32 v37, 0xffff0000, v40
    v_cvt_pk_bf16_f32 v40, v50, v51
    v_lshlrev_b32 v38, 16, v40
    v_and_b32 v39, 0xffff0000, v40
    s_mov_b32 s80, 0x3d372713
    s_mov_b32 s81, 0xc0135761
    v_mul_f32 v44, v32, v32
    v_fma_f32 v44, v44, s80, 1.0
    v_mul_f32 v44, v44, v32
    v_mul_f32 v44, s81, v44
    v_exp_f32 v44, v44
    v_mul_f32 v45, v33, v33
    v_fma_f32 v45, v45, s80, 1.0
    v_mul_f32 v45, v45, v33
    v_mul_f32 v45, s81, v45
    v_exp_f32 v45, v45
    v_mul_f32 v46, v34, v34
    v_fma_f32 v46, v46, s80, 1.0
    v_mul_f32 v46, v46, v34
    v_mul_f32 v46, s81, v46
    v_exp_f32 v46, v46
    v_mul_f32 v47, v35, v35
    v_fma_f32 v47, v47, s80, 1.0
    v_mul_f32 v47, v47, v35
    v_mul_f32 v47, s81, v47
    v_exp_f32 v47, v47
    s_nop 0
    v_add_f32 v44, 1.0, v44
    v_add_f32 v45, 1.0, v45
    v_add_f32 v46, 1.0, v46
    v_add_f32 v47, 1.0, v47
    v_rcp_f32 v44, v44
    v_rcp_f32 v45, v45
    v_rcp_f32 v46, v46
    v_rcp_f32 v47, v47
    s_nop 0
    v_mul_f32 v32, v32, v44
    v_mul_f32 v33, v33, v45
    v_mul_f32 v34, v34, v46
    v_mul_f32 v35, v35, v47
    v_cvt_pk_bf16_f32 v40, v32, v33
    v_lshlrev_b32 v32, 16, v40
    v_and_b32 v33, 0xffff0000, v40
    v_cvt_pk_bf16_f32 v40, v34, v35
    v_lshlrev_b32 v34, 16, v40
    v_and_b32 v35, 0xffff0000, v40
    v_mul_f32 v32, v32, v36
    v_mul_f32 v33, v33, v37
    v_mul_f32 v34, v34, v38
    v_mul_f32 v35, v35, v39
    v_cvt_pk_bf16_f32 v40, v32, v33
    v_cvt_pk_bf16_f32 v41, v34, v35
L_noffn2:
    ds_write_b64 v149, v[40:41]
    s_mov_b64 exec, 1
    ds_write_b32 v9, v23 offset:96
    s_mov_b64 exec, -1
L_w4_35:
    ds_read_b128 v[28:31], v8 offset:96
    ds_read_b64 v[120:121], v148 offset:0
    ds_read_b64 v[122:123], v148 offset:512
    ds_read_b64 v[124:125], v148 offset:1024
    ds_read_b64 v[126:127], v148 offset:1536
    ds_read_b64_tr_b16 v[112:113], v145 offset:0
    ds_read_b64_tr_b16 v[114:115], v145 offset:2048
    ds_read_b64_tr_b16 v[116:117], v145 offset:4096
    ds_read_b64_tr_b16 v[118:119], v145 offset:6144
    s_sub_u32 s15, s15, 1
    s_cbranch_scc1 L_abort
    s_waitcnt lgkmcnt(8)
    v_min3_i32 v28, v28, v29, v30
    v_min_i32 v28, v28, v31
    v_cmp_gt_i32 vcc, 1, v28
    s_waitcnt lgkmcnt(0)
    s_cbranch_vccnz L_w4_35
    v_mfma_f32_16x16x32_bf16 v[128:131], v[112:115], v[120:123], 0
    v_mfma_f32_16x16x32_bf16 v[128:131], v[116:119], v[124:127], v[128:131]
L_w_36:
    ds_read_b32 v20, v8 offset:16
    s_sub_u32 s15, s15, 1
    s_cbranch_scc1 L_abort
    s_waitcnt lgkmcnt(0)
    v_readfirstlane_b32 s65, v20
    s_cmp_ge_i32 s65, 88
    s_cbranch_scc0 L_w_36
L_w_37:
    ds_read_b32 v20, v8 offset:88
    s_sub_u32 s15, s15, 1
    s_cbranch_scc1 L_abort
    s_waitcnt lgkmcnt(0)
    v_readfirstlane_b32 s79, v20
    s_cmp_ge_i32 s79, 1
    s_cbranch_scc0 L_w_37
    s_mov_b32 s62, s79
L_mlpoll_38:
    buffer_load_dwordx4 v[44:47], v161, s[48:51], s69 offen offset:0 sc1
    buffer_load_dwordx4 v[48:51], v161, s[48:51], s69 offen offset:16 sc1
    buffer_load_dwordx4 v[52:55], v161, s[48:51], s69 offen offset:32 sc1
    buffer_load_dwordx4 v[56:59], v161, s[48:51], s69 offen offset:48 sc1
    s_sub_u32 s15, s15, 1
    s_cbranch_scc1 L_abort
    s_waitcnt vmcnt(0)
    v_xor_b32 v45, s67, v45
    v_xor_b32 v47, s67, v47
    v_xor_b32 v49, s67, v49
    v_xor_b32 v51, s67, v51
    v_xor_b32 v53, s67, v53
    v_xor_b32 v55, s67, v55
    v_xor_b32 v57, s67, v57
    v_xor_b32 v59, s67, v59
    v_or3_b32 v60, v45, v47, v49
    v_or3_b32 v61, v51, v53, v55
    v_or3_b32 v60, v60, v57, v59
    v_or_b32 v60, v60, v61
    v_cmp_ne_u32 vcc, 0, v60
    s_cbranch_vccnz L_mlpoll_38
    v_mov_b32 v16, -1
    v_mov_b32 v17, -1
    v_mov_b32 v18, -1
    v_mov_b32 v19, -1
    s_lshl_b32 s65, s10, 4
    s_add_u32 s65, s65, s60
    s_lshl_b32 s65, s65, 7
    s_add_u32 s65, s65, 0x10000
    s_mov_b32 exec_hi, 0
    s_cmp_eq_u32 s62, 2
    s_cbranch_scc0 L_far_39
    buffer_store_dwordx4 v[16:19], v154, s[48:51], s65 offen
    s_branch L_st_40
L_far_39:
    buffer_store_dwordx4 v[16:19], v154, s[48:51], s65 offen sc1
L_st_40:
    s_lshl_b32 s65, s5, 2
    s_add_u32 s65, s65, s96
    s_mov_b64 exec, 1
    v_mov_b32 v20, 2
    s_waitcnt vmcnt(0)
    s_cmp_eq_u32 s62, 2
    s_cbranch_scc0 L_far_41
    buffer_store_dword v164, v11, s[48:51], s65 offen
    s_branch L_st_42
L_far_41:
    buffer_store_dword v164, v11, s[48:51], s65 offen sc1
L_st_42:
    s_mov_b64 exec, 1
    ds_write_b32 v9, v20 offset:96
    s_mov_b64 exec, -1
    v_max3_f32 v26, v44, v48, v52
    v_max_f32 v26, v26, v56
    s_nop 1
    v_max_f32_dpp v26, v26, v26 row_ror:8 row_mask:0xf bank_mask:0xf
    v_mov_b32 v27, v26
    s_nop 1
    v_permlane16_swap_b32 v26, v27
    s_nop 0
    v_max_f32 v26, v26, v27
    v_sub_f32 v136, v44, v26
    v_sub_f32 v137, v48, v26
    v_sub_f32 v138, v52, v26
    v_sub_f32 v139, v56, v26
    v_exp_f32 v136, v136
    v_exp_f32 v137, v137
    v_exp_f32 v138, v138
    v_exp_f32 v139, v139
    v_mul_f32 v27, v136, v46
    v_fmac_f32 v27, v137, v50
    v_fmac_f32 v27, v138, v54
    v_fmac_f32 v27, v139, v58
    s_nop 1
    v_add_f32_dpp v27, v27, v27 row_ror:8 row_mask:0xf bank_mask:0xf
    v_mov_b32 v26, v27
    s_nop 1
    v_permlane16_swap_b32 v27, v26
    s_nop 0
    v_add_f32 v27, v27, v26
    v_rcp_f32 v27, v27
    s_add_u32 s76, s5, s60
    s_cmp_eq_u32 s76, 0
    s_cselect_b64 s[76:77], 1, 0
    v_mul_f32 v136, v136, v27
    v_mul_f32 v137, v137, v27
    v_mul_f32 v138, v138, v27
    v_mul_f32 v139, v139, v27
    s_mov_b32 m0, s83
    s_mov_b32 s80, 0x00ff00ff
    s_mov_b32 s81, s80
    s_mov_b32 s82, 0x01010101
    s_mov_b32 s83, s82
L_w_43:
    ds_read_b32 v20, v8 offset:16
    s_sub_u32 s15, s15, 1
    s_cbranch_scc1 L_abort
    s_waitcnt lgkmcnt(0)
    v_readfirstlane_b32 s65, v20
    s_cmp_ge_i32 s65, 104
    s_cbranch_scc0 L_w_43
    v_lshlrev_b32 v14, 2, v0
    s_mov_b32 exec_hi, 0
L_cpoll_44:
    buffer_load_dword v17, v14, s[48:51], s96 offen sc1
    s_sub_u32 s15, s15, 1
    s_cbranch_scc1 L_abort
    s_waitcnt vmcnt(0)
    v_cmp_ne_u32 vcc, v164, v17
    s_cbranch_vccnz L_cpoll_44
    s_mov_b32 exec_hi, -1
    s_branch L_tend
.p2align 6
L_tend:
    s_cbranch_execz L_tpad
L_w4_45:
    ds_read_b128 v[28:31], v8 offset:16
    s_sub_u32 s15, s15, 1
    s_cbranch_scc1 L_abort
    s_waitcnt lgkmcnt(0)
    v_min3_i32 v28, v28, v29, v30
    v_min_i32 v28, v28, v31
    v_cmp_gt_i32 vcc, 126, v28
    s_cbranch_vccnz L_w4_45
    s_setprio 2
    buffer_load_dwordx4 v4, s[40:43], s63 offen offset:0 nt lds
    buffer_load_dwordx4 v5, s[40:43], s63 offen offset:1024 nt lds
    buffer_load_dwordx4 v6, s[40:43], s63 offen offset:2048 nt lds
    buffer_load_dwordx4 v7, s[40:43], s63 offen offset:3072 nt lds
    s_waitcnt vmcnt(0)
    buffer_load_dwordx4 v[64:67], v162, s[48:51], s70 offen sc1
    buffer_load_dwordx4 v[68:71], v162, s[48:51], s71 offen sc1
    buffer_load_dwordx4 v[72:75], v162, s[48:51], s72 offen sc1
    buffer_load_dwordx4 v[76:79], v162, s[48:51], s73 offen sc1
    s_mov_b64 exec, 1
    ds_write_b32 v9, v23 offset:112
    s_mov_b64 exec, -1
L_w4_46:
    ds_read_b128 v[28:31], v8 offset:112
    ds_read_b64_tr_b16 v[96:97], v144 offset:0
    ds_read_b64_tr_b16 v[98:99], v144 offset:2048
    ds_read_b64_tr_b16 v[100:101], v144 offset:4096
    ds_read_b64_tr_b16 v[102:103], v144 offset:6144
    ds_read_b64_tr_b16 v[104:105], v144 offset:8192
    ds_read_b64_tr_b16 v[106:107], v144 offset:10240
    ds_read_b64_tr_b16 v[108:109], v144 offset:12288
    ds_read_b64_tr_b16 v[110:111], v144 offset:14336
    s_sub_u32 s15, s15, 1
    s_cbranch_scc1 L_abort
    s_waitcnt lgkmcnt(8)
    v_min3_i32 v28, v28, v29, v30
    v_min_i32 v28, v28, v31
    v_cmp_gt_i32 vcc, 1, v28
    s_waitcnt lgkmcnt(0)
    s_cbranch_vccnz L_w4_46
    s_branch L_ob
L_oa:
    s_mov_b64 exec, s[86:87]
    buffer_load_dwordx4 v[64:67], v162, s[48:51], s70 offen sc1
    s_mov_b64 exec, s[88:89]
    buffer_load_dwordx4 v[68:71], v162, s[48:51], s71 offen sc1
    s_mov_b64 exec, s[90:91]
    buffer_load_dwordx4 v[72:75], v162, s[48:51], s72 offen sc1
    s_mov_b64 exec, s[92:93]
    buffer_load_dwordx4 v[76:79], v162, s[48:51], s73 offen sc1
    s_mov_b64 exec, -1
    s_sub_u32 s15, s15, 1
    s_cbranch_scc1 L_abort
L_ob:
    s_waitcnt vmcnt(3)
    v_max3_u32 v20, v64, v65, v66
    v_max_u32 v20, v20, v67
    v_cmp_eq_u32 s[86:87], -1, v20
    s_waitcnt vmcnt(2)
    v_max3_u32 v20, v68, v69, v70
    v_max_u32 v20, v20, v71
    v_cmp_eq_u32 s[88:89], -1, v20
    s_waitcnt vmcnt(1)
    v_max3_u32 v20, v72, v73, v74
    v_max_u32 v20, v20, v75
    v_cmp_eq_u32 s[90:91], -1, v20
    s_waitcnt vmcnt(0)
    v_max3_u32 v20, v76, v77, v78
    v_max_u32 v20, v20, v79
    v_cmp_eq_u32 s[92:93], -1, v20
    s_or_b64 s[94:95], s[86:87], s[88:89]
    s_or_b64 s[94:95], s[94:95], s[90:91]
    s_or_b64 s[94:95], s[94:95], s[92:93]
    s_cbranch_scc1 L_oa
    v_mul_f32 v132, v64, v136
    v_mul_f32 v133, v65, v136
    v_mul_f32 v134, v66, v136
    v_mul_f32 v135, v67, v136
    v_fmac_f32 v132, v68, v137
    v_fmac_f32 v134, v70, v137
    v_fmac_f32 v133, v69, v137
    v_fmac_f32 v135, v71, v137
    v_fmac_f32 v132, v72, v138
    v_fmac_f32 v134, v74, v138
    v_fmac_f32 v133, v73, v138
    v_fmac_f32 v135, v75, v138
    v_fmac_f32 v132, v76, v139
    v_fmac_f32 v134, v78, v139
    v_fmac_f32 v133, v77, v139
    v_fmac_f32 v135, v79, v139
    v_permlane16_swap_b32 v132, v134
    s_nop 0
    v_permlane16_swap_b32 v133, v135
    v_add_f32 v132, v132, v134
    v_add_f32 v133, v133, v135
    s_nop 0
    v_add_f32_dpp v132, v132, v132 row_ror:8 row_mask:0xf bank_mask:0xf
    v_add_f32_dpp v133, v133, v133 row_ror:8 row_mask:0xf bank_mask:0xf
    s_mov_b64 exec, s[80:81]
    v_cvt_pk_bf16_f32 v24, v132, v133
    ds_write_b32 v147, v24
    s_mov_b64 exec, 1
    ds_write_b32 v9, v23 offset:0
    s_mov_b64 exec, -1
    s_mov_b64 exec, s[76:77]
    s_cbranch_execnz L_ind
L_noind:
    s_mov_b64 exec, -1
L_w4_47:
    ds_read_b128 v[28:31], v8 offset:0
    ds_read_b128 v[32:35], v146 offset:0
    ds_read_b128 v[36:39], v146 offset:128
    ds_read_b128 v[40:43], v146 offset:256
    ds_read_b128 v[44:47], v146 offset:384
    s_sub_u32 s15, s15, 1
    s_cbranch_scc1 L_abort
    s_waitcnt lgkmcnt(4)
    v_min3_i32 v28, v28, v29, v30
    v_min_i32 v28, v28, v31
    v_cmp_gt_i32 vcc, 1, v28
    s_waitcnt lgkmcnt(0)
    s_cbranch_vccnz L_w4_47
    v_mfma_f32_16x16x32_bf16 v[128:131], v[96:99], v[32:35], v[128:131]
    v_mfma_f32_16x16x32_bf16 v[128:131], v[100:103], v[36:39], v[128:131]
    v_mfma_f32_16x16x32_bf16 v[128:131], v[104:107], v[40:43], v[128:131]
    v_mfma_f32_16x16x32_bf16 v[128:131], v[108:111], v[44:47], v[128:131]
    s_nop 6
    s_mov_b64 exec, s[82:83]
    v_and_or_b32 v128, v128, s85, v150
    v_and_or_b32 v129, v129, s85, v151
    v_and_or_b32 v130, v130, s85, v152
    v_and_or_b32 v131, v131, s85, v153
    buffer_store_dwordx4 v[128:131], v163, s[48:51], s74 offen sc1
    s_endpgm
L_ind:
    buffer_store_dword v164, v11, s[48:51], s78 offen sc1
    s_branch L_noind
L_abort:
    s_endpgm
L_ctl:
    s_cmp_eq_u32 s62, 2
    s_cbranch_scc1 L_ctl_init
    s_waitcnt lgkmcnt(0)
    v_add_u32 v15, v12, v13
    v_mov_b32 v24, s62
    v_readfirstlane_b32 s78, v23
    s_mov_b64 exec, 1
    buffer_store_dword v24, v11, s[44:47], s72 offen
    s_mov_b64 exec, 0xffff
    v_add_u32_dpp v15, v15, v15 quad_perm:[1,0,3,2] row_mask:0xf bank_mask:0xf
    buffer_load_dwordx2 v[12:13], v14, s[44:47], s73 offen sc1
    ds_read_b32 v23, v8 offset:88
    v_add_u32_dpp v15, v15, v15 quad_perm:[2,3,0,1] row_mask:0xf bank_mask:0xf
    v_min3_i32 v20, v16, v17, v18
    s_add_u32 s63, s63, 4
    v_add_u32_dpp v15, v15, v15 row_half_mirror row_mask:0xf bank_mask:0xf
    v_min_i32 v20, v20, v19
    s_add_u32 s70, s70, 32768
    v_add_u32_dpp v15, v15, v15 row_mirror row_mask:0xf bank_mask:0xf
    v_readfirstlane_b32 s66, v20
    v_readfirstlane_b32 s76, v15
    s_mov_b64 exec, -1
    s_mul_i32 s76, s76, 256
    s_sub_i32 s76, s76, s70
    s_ashr_i32 s76, s76, 13
    s_max_i32 s76, s76, -2
    s_min_i32 s76, s76, 3
    s_cmp_eq_u32 s71, 2
    s_cselect_b32 s68, s76, s68
    s_mov_b32 s71, s78
    s_bitcmp1_b32 s62, 6
    s_branch L_event3
L_ctl_init:
    s_lshr_b32 s72, s10, 4
    s_lshl_b32 s72, s72, 2
    s_and_b32 s73, s7, 3
    s_add_u32 s72, s72, s73
    s_lshl_b32 s72, s72, 4
    s_and_b32 s73, s7, 12
    s_add_u32 s72, s72, s73
    s_add_u32 s72, s72, 0x1000
    s_and_b32 s73, s72, 0xffffff80
    s_lshr_b32 s63, s5, 2
    s_add_u32 s63, s63, s5
    s_and_b32 s63, s63, 3
    s_add_u32 s63, s63, 3
    s_mov_b32 s71, 0
    s_sub_u32 s70, s63, 8
    s_mul_i32 s70, s70, 8192
    s_cmp_eq_u32 s4, 7
    s_cselect_b32 s74, 0, 0
    s_add_u32 s74, s74, 23511
    s_sub_u32 s70, s70, s74
    s_getreg_b32 s74, hwreg(HW_REG_XCC_ID, 0, 1)
    s_mul_i32 s74, s74, 1228
    s_add_u32 s70, s70, s74
    v_mov_b32 v12, 0
    v_mov_b32 v13, 0
    v_mov_b32 v23, 0
    s_branch L_event2
L_var:
    s_cmp_ge_i32 s68, 1
    s_cbranch_scc1 L_tr_48
    s_cmp_ge_i32 s68, -1
    s_cbranch_scc1 L_tr_49
    v_add_u32 v21, 2, v22
L_body0:
    s_waitcnt vmcnt(15)
    buffer_load_dwordx4 v4, s[40:43], s60 offen offset:0 nt lds
    v_add_u32 v21, 1, v21
    s_add_u32 s61, s60, 0x8000
    s_waitcnt vmcnt(15)
    buffer_load_dwordx4 v5, s[40:43], s60 offen offset:1024 nt lds
    s_or_b32 s65, s65, 0x8000
    s_add_u32 s65, s65, 0x1000
    s_waitcnt vmcnt(15)
    buffer_load_dwordx4 v6, s[40:43], s60 offen offset:2048 nt lds
    s_and_b32 s65, s65, 0x77000
    s_waitcnt vmcnt(15)
    buffer_load_dwordx4 v7, s[40:43], s60 offen offset:3072 nt lds
    s_add_u32 m0, m0, 0x1000
    s_waitcnt vmcnt(15)
    buffer_load_dwordx4 v4, s[40:43], s61 offen offset:0 nt lds
    s_xor_b32 s60, s65, s64
    s_waitcnt vmcnt(15)
    buffer_load_dwordx4 v5, s[40:43], s61 offen offset:1024 nt lds
    s_add_u32 s62, s62, 1
    s_waitcnt vmcnt(15)
    buffer_load_dwordx4 v6, s[40:43], s61 offen offset:2048 nt lds
    s_add_u32 s66, m0, 0x1000
    s_waitcnt vmcnt(15)
    buffer_load_dwordx4 v7, s[40:43], s61 offen offset:3072 nt lds
    ds_max_i32 v9, v21 offset:256
    s_and_b32 m0, s66, 0x1ffff
    s_cmp_lg_u32 s62, s69
    s_cbranch_scc1 L_body0
    s_branch L_event
L_tr_49:
    v_add_u32 v21, 1, v22
L_body1:
    s_waitcnt vmcnt(17)
    buffer_load_dwordx4 v4, s[40:43], s60 offen offset:0 nt lds
    v_add_u32 v21, 1, v21
    s_add_u32 s61, s60, 0x8000
    s_waitcnt vmcnt(17)
    buffer_load_dwordx4 v5, s[40:43], s60 offen offset:1024 nt lds
    ds_max_i32 v9, v21 offset:256
    s_or_b32 s65, s65, 0x8000
    s_add_u32 s65, s65, 0x1000
    s_waitcnt vmcnt(17)
    buffer_load_dwordx4 v6, s[40:43], s60 offen offset:2048 nt lds
    s_and_b32 s65, s65, 0x77000
    s_waitcnt vmcnt(17)
    buffer_load_dwordx4 v7, s[40:43], s60 offen offset:3072 nt lds
    s_add_u32 m0, m0, 0x1000
    s_waitcnt vmcnt(17)
    buffer_load_dwordx4 v4, s[40:43], s61 offen offset:0 nt lds
    s_xor_b32 s60, s65, s64
    s_waitcnt vmcnt(17)
    buffer_load_dwordx4 v5, s[40:43], s61 offen offset:1024 nt lds
    s_add_u32 s62, s62, 1
    s_waitcnt vmcnt(17)
    buffer_load_dwordx4 v6, s[40:43], s61 offen offset:2048 nt lds
    s_add_u32 s66, m0, 0x1000
    s_waitcnt vmcnt(17)
    buffer_load_dwordx4 v7, s[40:43], s61 offen offset:3072 nt lds
    s_and_b32 m0, s66, 0x1ffff
    s_cmp_lg_u32 s62, s69
    s_cbranch_scc1 L_body1
    s_branch L_event
L_tr_48:
    s_cmp_ge_i32 s68, 2
    s_cbranch_scc1 L_tr_50
    v_add_u32 v21, 1, v22
L_body3:
    s_waitcnt vmcnt(21)
    buffer_load_dwordx4 v4, s[40:43], s60 offen offset:0 nt lds
    v_add_u32 v21, 1, v21
    s_add_u32 s61, s60, 0x8000
    s_waitcnt vmcnt(21)
    buffer_load_dwordx4 v5, s[40:43], s60 offen offset:1024 nt lds
    s_or_b32 s65, s65, 0x8000
    s_add_u32 s65, s65, 0x1000
    s_waitcnt vmcnt(21)
    buffer_load_dwordx4 v6, s[40:43], s60 offen offset:2048 nt lds
    s_and_b32 s65, s65, 0x77000
    s_waitcnt vmcnt(21)
    buffer_load_dwordx4 v7, s[40:43], s60 offen offset:3072 nt lds
    s_add_u32 m0, m0, 0x1000
    s_waitcnt vmcnt(21)
    buffer_load_dwordx4 v4, s[40:43], s61 offen offset:0 nt lds
    s_xor_b32 s60, s65, s64
    s_waitcnt vmcnt(21)
    buffer_load_dwordx4 v5, s[40:43], s61 offen offset:1024 nt lds
    ds_max_i32 v9, v21 offset:256
    s_add_u32 s62, s62, 1
    s_waitcnt vmcnt(21)
    buffer_load_dwordx4 v6, s[40:43], s61 offen offset:2048 nt lds
    s_add_u32 s66, m0, 0x1000
    s_waitcnt vmcnt(21)
    buffer_load_dwordx4 v7, s[40:43], s61 offen offset:3072 nt lds
    s_and_b32 m0, s66, 0x1ffff
    s_cmp_lg_u32 s62, s69
    s_cbranch_scc1 L_body3
    s_branch L_event
L_tr_50:
    s_cmp_ge_i32 s68, 3
    s_cbranch_scc1 L_tr_51
    v_add_u32 v21, 1, v22
L_body4:
    s_waitcnt vmcnt(23)
    buffer_load_dwordx4 v4, s[40:43], s60 offen offset:0 nt lds
    v_add_u32 v21, 1, v21
    s_add_u32 s61, s60, 0x8000
    s_waitcnt vmcnt(23)
    buffer_load_dwordx4 v5, s[40:43], s60 offen offset:1024 nt lds
    s_or_b32 s65, s65, 0x8000
    s_add_u32 s65, s65, 0x1000
    s_waitcnt vmcnt(23)
    buffer_load_dwordx4 v6, s[40:43], s60 offen offset:2048 nt lds
    s_and_b32 s65, s65, 0x77000
    s_waitcnt vmcnt(23)
    buffer_load_dwordx4 v7, s[40:43], s60 offen offset:3072 nt lds
    s_add_u32 m0, m0, 0x1000
    s_waitcnt vmcnt(23)
    buffer_load_dwordx4 v4, s[40:43], s61 offen offset:0 nt lds
    s_xor_b32 s60, s65, s64
    s_waitcnt vmcnt(23)
    buffer_load_dwordx4 v5, s[40:43], s61 offen offset:1024 nt lds
    s_add_u32 s62, s62, 1
    s_waitcnt vmcnt(23)
    buffer_load_dwordx4 v6, s[40:43], s61 offen offset:2048 nt lds
    s_add_u32 s66, m0, 0x1000
    s_waitcnt vmcnt(23)
    buffer_load_dwordx4 v7, s[40:43], s61 offen offset:3072 nt lds
    ds_max_i32 v9, v21 offset:256
    s_and_b32 m0, s66, 0x1ffff
    s_cmp_lg_u32 s62, s69
    s_cbranch_scc1 L_body4
    s_branch L_event
L_tr_51:
    v_add_u32 v21, 0, v22
L_body5:
    s_waitcnt vmcnt(25)
    buffer_load_dwordx4 v4, s[40:43], s60 offen offset:0 nt lds
    v_add_u32 v21, 1, v21
    s_add_u32 s61, s60, 0x8000
    s_waitcnt vmcnt(25)
    buffer_load_dwordx4 v5, s[40:43], s60 offen offset:1024 nt lds
    ds_max_i32 v9, v21 offset:256
    s_or_b32 s65, s65, 0x8000
    s_add_u32 s65, s65, 0x1000
    s_waitcnt vmcnt(25)
    buffer_load_dwordx4 v6, s[40:43], s60 offen offset:2048 nt lds
    s_and_b32 s65, s65, 0x77000
    s_waitcnt vmcnt(25)
    buffer_load_dwordx4 v7, s[40:43], s60 offen offset:3072 nt lds
    s_add_u32 m0, m0, 0x1000
    s_waitcnt vmcnt(25)
    buffer_load_dwordx4 v4, s[40:43], s61 offen offset:0 nt lds
    s_xor_b32 s60, s65, s64
    s_waitcnt vmcnt(25)
    buffer_load_dwordx4 v5, s[40:43], s61 offen offset:1024 nt lds
    s_add_u32 s62, s62, 1
    s_waitcnt vmcnt(25)
    buffer_load_dwordx4 v6, s[40:43], s61 offen offset:2048 nt lds
    s_add_u32 s66, m0, 0x1000
    s_waitcnt vmcnt(25)
    buffer_load_dwordx4 v7, s[40:43], s61 offen offset:3072 nt lds
    s_and_b32 m0, s66, 0x1ffff
    s_cmp_lg_u32 s62, s69
    s_cbranch_scc1 L_body5
    s_branch L_event
L_end:
.section .rodata,"a"
.p2align 6
.amdhsa_kernel parallel_sum__gqa_block_cached__geglu_ffn__decode_kernel
  .amdhsa_next_free_vgpr 168
  .amdhsa_next_free_sgpr 102
  .amdhsa_accum_offset 168
  .amdhsa_group_segment_fixed_size 0
  .amdhsa_kernarg_size 96
  .amdhsa_user_sgpr_count 2
  .amdhsa_user_sgpr_kernarg_segment_ptr 1
  .amdhsa_system_sgpr_workgroup_id_x 1
.end_amdhsa_kernel
```
